```python
import torch

def _softmax(x, axis=-1):
    return torch.softmax(x, dim=axis)
def _gelu(x):
    return torch.nn.functional.gelu(x, approximate="tanh")
def _silu(x):
    return torch.nn.functional.silu(x)
def _sigmoid(x):
    return torch.sigmoid(x)
def _layernorm(x, axis=-1, eps=1e-5):
    m = x.mean(dim=axis, keepdim=True)
    v = x.var(dim=axis, keepdim=True, unbiased=False)
    return (x - m) / torch.sqrt(v + eps)
def _scatter_add(tgt, idx, src, axis=0):
    return tgt.clone().index_add_(axis, idx, src)
def _segment_sum(src, seg, n):
    out = torch.zeros((n,) + src.shape[1:], dtype=src.dtype)
    return out.index_add_(0, seg, src)
def _pad(x, pw):
    flat = tuple(v for pair in reversed(pw) for v in pair)
    return torch.nn.functional.pad(x, flat)

kernel_name = 'standalone__adm_resblock__diffusion'

def setup_inputs():

    _w = (lambda a: (lambda t: t.to(torch.bfloat16) if t.is_floating_point() else t)(torch.as_tensor(a)))
    B, C, HW, E = 2, 128, 64, 384
    sc = (9.0 * C) ** -0.5
    return {
        "x": _w((lambda *s: torch.randn(*s, dtype=torch.bfloat16) * 0.05)(B, C, HW, HW)),
        "t_emb": _w((lambda *s: torch.randn(*s, dtype=torch.bfloat16) * 0.4)(B, E)),
        "g1": _w(1.0 + 0.1 * (lambda *s: torch.randn(*s, dtype=torch.bfloat16) * 0.4)(C)),
        "be1": _w(0.1 * (lambda *s: torch.randn(*s, dtype=torch.bfloat16) * 0.4)(C)),
        "w1": _w((lambda *s: torch.randn(*s, dtype=torch.bfloat16) * 0.4)(C, C, 3, 3) * sc),
        "w_emb": _w((lambda *s: torch.randn(*s, dtype=torch.bfloat16) * 0.4)(E, C) * (E ** -0.5)),
        "g2": _w(1.0 + 0.1 * (lambda *s: torch.randn(*s, dtype=torch.bfloat16) * 0.4)(C)),
        "be2": _w(0.1 * (lambda *s: torch.randn(*s, dtype=torch.bfloat16) * 0.4)(C)),
        "w2": _w((lambda *s: torch.randn(*s, dtype=torch.bfloat16) * 0.4)(C, C, 3, 3) * sc),
    }

def reference(x, t_emb, g1, be1, w1, w_emb, g2, be2, w2):
    B, C, H, W = x.shape
    G, eps = 4, 1e-5
    def gn(z, gamma, beta):
        zr = z.reshape(B, G, (C // G) * H * W)
        mu = zr.mean(-1).reshape(B, G, 1)
        var = ((zr - mu) ** 2).mean(-1).reshape(B, G, 1)
        zn = ((zr - mu) / torch.sqrt(var + eps)).reshape(B, C, H, W)
        return zn * gamma.reshape(1, C, 1, 1) + beta.reshape(1, C, 1, 1)
    def conv3(z, w):
        zp = _pad(z, ((0, 0), (0, 0), (1, 1), (1, 1)))
        taps = [torch.einsum("bchw,oc->bohw", zp[:, :, i:i+H, j:j+W], w[:, :, i, j]) for i in range(3) for j in range(3)]
        out = taps[0]
        for t in taps[1:]:
            out = out + t
        return out
    h = conv3(_silu(gn(x, g1, be1)), w1)
    emb = _silu(t_emb) @ w_emb
    h = h + emb.reshape(B, C, 1, 1)
    h = conv3(_silu(gn(h, g2, be2)), w2)
    return x + h
```

```asm
; @launch grid=(256,1,1) block=(512,1,1) lds=102912
.amdgcn_target "amdgcn-amd-amdhsa--gfx950"
.text
.globl standalone__adm_resblock__diffusion_kernel
.p2align 8
.type standalone__adm_resblock__diffusion_kernel,@function
standalone__adm_resblock__diffusion_kernel:
    s_cmp_ge_u32 s2, 256
    s_cbranch_scc1 end
    s_load_dwordx16 s[4:19], s[0:1], 0
    s_load_dwordx8 s[20:27], s[0:1], 64
    v_and_b32 v1, 63, v0
    v_lshrrev_b32 v2, 6, v0
    s_bfe_u32 s28, s2, 0x10002
    s_and_b32 s35, s2, 3
    s_lshr_b32 s36, s2, 3
    v_readfirstlane_b32 s33, v2
    s_lshl_b32 s29, s35, 5
    s_or_b32 s29, s29, s36
    s_and_b32 s30, s36, 1
    s_lshr_b32 s31, s36, 3
    s_lshl_b32 s35, s35, 2
    s_or_b32 s31, s31, s35
    s_bfe_u32 s32, s36, 0x20001
    s_mov_b32 s56, 0xbfb8aa3b
    s_mov_b32 s57, 0xbfb8aa3b
    s_mov_b32 s58, 1.0
    s_mov_b32 s59, 1.0
    s_movk_i32 s60, 272
    v_lshlrev_b32 v24, 1, v1
    v_add_u32 v25, 8192, v24
    v_add_u32 v26, 16384, v24
    v_add_u32 v27, 24576, v24
    v_add_u32 v28, 32768, v24
    v_add_u32 v29, 40960, v24
    v_add_u32 v30, 49152, v24
    v_add_u32 v31, 57344, v24
    v_and_b32 v2, 255, v0
    v_min_u32 v2, 143, v2
    v_mul_u32_u24 v3, 3641, v2
    v_lshrrev_b32 v3, 16, v3
    v_mul_u32_u24 v4, 18, v3
    v_sub_u32 v4, v2, v4
    v_mul_u32_u24 v3, 2304, v3
    v_lshl_add_u32 v3, v4, 4, v3
    s_lshr_b32 s36, s29, 3
    s_and_b32 s37, s29, 7
    s_mul_i32 s38, s36, 18432
    s_mul_i32 s39, s37, 288
    s_add_u32 s38, s38, s39
    v_add_u32 v3, s38, v3
    v_lshrrev_b32 v5, 3, v0
    v_lshlrev_b32 v5, 13, v5
    v_bfe_u32 v6, v0, 1, 2
    v_lshl_add_u32 v5, v6, 7, v5
    v_and_b32 v6, 1, v0
    v_lshl_add_u32 v5, v6, 4, v5
    s_lshl_b32 s38, s28, 20
    s_lshl_b32 s39, s30, 19
    s_add_u32 s38, s38, s39
    s_lshl_b32 s39, s31, 9
    s_add_u32 s38, s38, s39
    s_lshl_b32 s39, s32, 5
    s_add_u32 s38, s38, s39
    v_add_u32 v67, s38, v5
    v_and_b32 v6, 7, v0
    v_lshlrev_b32 v6, 4, v6
    v_min_u32 v7, 47, v1
    s_and_b32 s38, s29, 7
    s_mul_i32 s38, s38, 48
    v_add_u32 v7, s38, v7
    v_lshlrev_b32 v22, 1, v7
    s_mul_i32 s39, s28, 768
    v_add_u32 v22, s39, v22
    v_lshlrev_b32 v7, 8, v7
    s_lshr_b32 s39, s29, 3
    s_lshl_b32 s39, s39, 4
    v_add_u32 v7, s39, v7
    s_waitcnt lgkmcnt(0)
    s_lshl_b32 s38, s28, 20
    s_lshl_b32 s39, s30, 19
    s_add_u32 s38, s38, s39
    s_lshl_b32 s39, s33, 16
    s_add_u32 s38, s38, s39
    s_lshr_b32 s39, s29, 1
    s_lshl_b32 s39, s39, 7
    s_add_u32 s38, s38, s39
    s_add_u32 s36, s4, s38
    s_addc_u32 s37, s5, 0
    global_load_ushort v16, v24, s[36:37]
    global_load_ushort v17, v25, s[36:37]
    global_load_ushort v18, v26, s[36:37]
    global_load_ushort v19, v27, s[36:37]
    global_load_ushort v8, v28, s[36:37]
    global_load_ushort v9, v29, s[36:37]
    global_load_ushort v10, v30, s[36:37]
    global_load_ushort v11, v31, s[36:37]
    s_cmp_lt_u32 s33, 4
    s_cselect_b32 s38, s12, s20
    s_cselect_b32 s39, s13, s21
    global_load_dwordx4 v[48:51], v3, s[38:39]
    s_cmp_eq_u32 s33, 3
    s_cbranch_scc0 a_noe
    global_load_ushort v116, v22, s[6:7]
    global_load_dwordx4 v[112:115], v7, s[14:15]
a_noe:
    s_lshl_b32 s38, s28, 8
    s_add_u32 s62, s26, s38
    s_addc_u32 s63, s27, 0
    s_load_dword s34, s[62:63], 0
    s_lshl_b32 s38, s28, 12
    s_add_u32 s90, s26, s38
    s_addc_u32 s91, s27, 0
    s_add_u32 s92, s90, 16384
    s_addc_u32 s93, s91, 0
    s_add_u32 s90, s90, 4096
    s_addc_u32 s91, s91, 0
    s_lshl_b32 s38, s29, 5
    s_add_u32 s94, s90, s38
    s_addc_u32 s95, s91, 0
    s_add_u32 s96, s92, s38
    s_addc_u32 s97, s93, 0
    s_lshl_b32 s38, s28, 21
    s_add_u32 s38, s38, 2097152
    s_add_u32 s88, s26, s38
    s_addc_u32 s89, s27, 0
    s_add_u32 s98, s88, 4194304
    s_addc_u32 s99, s89, 0
    s_mul_i32 s38, s28, 589824
    s_add_u32 s38, s38, 65536
    s_add_u32 s100, s26, s38
    s_addc_u32 s101, s27, 0
    s_lshl_b32 s38, s28, 12
    s_add_u32 s38, s38, 32768
    s_add_u32 s24, s26, s38
    s_addc_u32 s25, s27, 0
    s_waitcnt vmcnt(1)
    global_load_dwordx4 v[76:79], v67, s[4:5]
    global_load_dwordx4 v[96:99], v6, s[8:9]
    global_load_dwordx4 v[100:103], v6, s[10:11]
    global_load_dwordx4 v[104:107], v6, s[8:9] offset:128
    global_load_dwordx4 v[108:111], v6, s[10:11] offset:128
    v_lshl_or_b32 v16, v17, 16, v16
    v_lshl_or_b32 v17, v19, 16, v18
    v_lshl_or_b32 v18, v9, 16, v8
    v_lshl_or_b32 v19, v11, 16, v10
    v_mul_u32_u24 v20, 144, v1
    s_lshl_b32 s38, s33, 4
    s_add_u32 s38, s38, 30720
    v_add_u32 v20, s38, v20
    ds_write_b128 v20, v[16:19]
    v_mov_b32 v21, 0x3f803f80
    v_mov_b32 v4, 0
    v_mov_b32 v5, 0
    v_dot2_f32_bf16 v4, v16, v21, v4
    v_dot2_f32_bf16 v5, v16, v16, v5
    v_dot2_f32_bf16 v4, v17, v21, v4
    v_dot2_f32_bf16 v5, v17, v17, v5
    v_dot2_f32_bf16 v4, v18, v21, v4
    v_dot2_f32_bf16 v5, v18, v18, v5
    v_dot2_f32_bf16 v4, v19, v21, v4
    v_dot2_f32_bf16 v5, v19, v19, v5
    s_nop 3
    v_add_f32_dpp v4, v4, v4 row_ror:8 row_mask:0xf bank_mask:0xf
    v_add_f32_dpp v5, v5, v5 row_ror:8 row_mask:0xf bank_mask:0xf
    s_nop 0
    v_add_f32_dpp v4, v4, v4 row_ror:4 row_mask:0xf bank_mask:0xf
    v_add_f32_dpp v5, v5, v5 row_ror:4 row_mask:0xf bank_mask:0xf
    s_nop 0
    v_add_f32_dpp v4, v4, v4 row_ror:2 row_mask:0xf bank_mask:0xf
    v_add_f32_dpp v5, v5, v5 row_ror:2 row_mask:0xf bank_mask:0xf
    s_nop 0
    v_add_f32_dpp v4, v4, v4 row_ror:1 row_mask:0xf bank_mask:0xf
    v_add_f32_dpp v5, v5, v5 row_ror:1 row_mask:0xf bank_mask:0xf
    s_nop 0
    v_mov_b32 v20, v4
    v_mov_b32 v21, v5
    s_nop 1
    v_permlane16_swap_b32 v4, v20
    v_permlane16_swap_b32 v5, v21
    s_nop 1
    v_add_f32 v4, v4, v20
    v_add_f32 v5, v5, v21
    s_nop 1
    v_mov_b32 v20, v4
    v_mov_b32 v21, v5
    s_nop 1
    v_permlane32_swap_b32 v4, v20
    v_permlane32_swap_b32 v5, v21
    s_nop 1
    v_add_f32 v4, v4, v20
    v_add_f32 v5, v5, v21
    s_nop 1
    s_lshr_b32 s39, s33, 2
    v_cmp_eq_u32 vcc, s39, v1
    s_lshl_b32 s38, s33, 4
    s_add_u32 s38, s38, 100416
    v_lshlrev_b32 v20, 3, v1
    v_add_u32 v20, s38, v20
    v_cndmask_b32 v4, 0, v4, vcc
    v_cndmask_b32 v5, 0, v5, vcc
    s_mov_b64 exec, 3
    ds_write_b64 v20, v[4:5]
    s_mov_b64 exec, -1
    v_lshrrev_b32 v20, 8, v0
    v_mul_u32_u24 v20, 2304, v20
    v_lshl_add_u32 v20, v2, 4, v20
    s_waitcnt vmcnt(5)
    ds_write_b128 v20, v[48:51] offset:39936
    s_waitcnt lgkmcnt(0)
    s_barrier
    v_lshrrev_b32 v20, 3, v0
    v_mul_u32_u24 v21, 144, v20
    v_and_b32 v22, 7, v0
    v_lshl_add_u32 v21, v22, 4, v21
    ds_read_b128 v[16:19], v21 offset:30720
    v_lshlrev_b32 v20, 8, v20
    v_lshl_add_u32 v20, v22, 4, v20
    s_lshr_b32 s38, s29, 1
    s_lshl_b32 s38, s38, 14
    s_lshl_b32 s39, s30, 7
    s_add_u32 s38, s38, s39
    v_add_u32 v20, s38, v20
    v_lshrrev_b32 v24, 4, v2
    v_bfe_u32 v25, v2, 3, 1
    v_and_b32 v26, 7, v2
    v_mul_u32_u24 v27, 288, v26
    v_mul_u32_u24 v28, 144, v25
    v_add_u32 v27, v27, v28
    v_lshl_add_u32 v27, v24, 1, v27
    v_lshrrev_b32 v28, 8, v0
    v_mul_u32_u24 v29, 2304, v28
    v_add_u32 v27, v27, v29
    ds_read_u16 v32, v27 offset:39936
    ds_read_u16 v33, v27 offset:39954
    ds_read_u16 v34, v27 offset:39972
    ds_read_u16 v35, v27 offset:39990
    ds_read_u16 v36, v27 offset:40008
    ds_read_u16 v37, v27 offset:40026
    ds_read_u16 v38, v27 offset:40044
    ds_read_u16 v39, v27 offset:40062
    s_lshr_b32 s36, s29, 3
    s_and_b32 s37, s29, 7
    s_lshr_b32 s38, s36, 2
    s_lshl_b32 s38, s38, 2
    s_lshr_b32 s39, s37, 1
    s_add_u32 s38, s38, s39
    s_mul_i32 s38, s38, 18432
    s_and_b32 s39, s37, 1
    s_mul_i32 s39, s39, 9216
    s_add_u32 s38, s38, s39
    s_and_b32 s39, s36, 3
    s_lshl_b32 s39, s39, 7
    s_add_u32 s38, s38, s39
    v_mul_u32_u24 v28, 294912, v28
    v_lshl_add_u32 v28, v24, 10, v28
    v_lshl_add_u32 v28, v25, 9, v28
    v_lshl_add_u32 v28, v26, 4, v28
    v_add_u32 v28, s38, v28
    s_waitcnt lgkmcnt(8)
    global_store_dwordx4 v20, v[16:19], s[88:89] sc0 sc1
    s_waitcnt lgkmcnt(0)
    v_lshl_or_b32 v32, v33, 16, v32
    v_lshl_or_b32 v33, v35, 16, v34
    v_lshl_or_b32 v34, v37, 16, v36
    v_lshl_or_b32 v35, v39, 16, v38
    v_and_b32 v24, 255, v0
    v_cmp_gt_u32 vcc, 144, v24
    s_and_saveexec_b64 s[42:43], vcc
    s_cbranch_execz nowf
    global_store_dwordx4 v28, v[32:35], s[100:101] sc0 sc1
nowf:
    s_mov_b64 exec, -1
    s_cmp_eq_u32 s33, 3
    s_cbranch_scc0 a_noemb
    v_lshlrev_b32 v116, 16, v116
    v_mul_f32 v16, s56, v116
    v_exp_f32 v16, v16
    v_cmp_gt_u32 vcc, 48, v1
    v_add_f32 v16, 1.0, v16
    v_rcp_f32 v16, v16
    s_nop 0
    v_mul_f32 v116, v116, v16
    v_cndmask_b32 v116, 0, v116, vcc
    v_lshlrev_b32 v16, 16, v112
    v_and_b32 v17, 0xffff0000, v112
    v_lshlrev_b32 v18, 16, v113
    v_and_b32 v19, 0xffff0000, v113
    v_lshlrev_b32 v20, 16, v114
    v_and_b32 v21, 0xffff0000, v114
    v_lshlrev_b32 v22, 16, v115
    v_and_b32 v23, 0xffff0000, v115
    v_pk_mul_f32 v[16:17], v[16:17], v[116:117] op_sel_hi:[1,0]
    v_pk_mul_f32 v[18:19], v[18:19], v[116:117] op_sel_hi:[1,0]
    v_pk_mul_f32 v[20:21], v[20:21], v[116:117] op_sel_hi:[1,0]
    v_pk_mul_f32 v[22:23], v[22:23], v[116:117] op_sel_hi:[1,0]
    s_nop 1
    v_add_f32_dpp v16, v16, v16 row_ror:8 row_mask:0xf bank_mask:0xf
    v_add_f32_dpp v17, v17, v17 row_ror:8 row_mask:0xf bank_mask:0xf
    v_add_f32_dpp v18, v18, v18 row_ror:8 row_mask:0xf bank_mask:0xf
    v_add_f32_dpp v19, v19, v19 row_ror:8 row_mask:0xf bank_mask:0xf
    v_add_f32_dpp v20, v20, v20 row_ror:8 row_mask:0xf bank_mask:0xf
    v_add_f32_dpp v21, v21, v21 row_ror:8 row_mask:0xf bank_mask:0xf
    v_add_f32_dpp v22, v22, v22 row_ror:8 row_mask:0xf bank_mask:0xf
    v_add_f32_dpp v23, v23, v23 row_ror:8 row_mask:0xf bank_mask:0xf
    s_nop 1
    v_permlane16_swap_b32 v16, v17
    v_permlane16_swap_b32 v18, v19
    v_permlane16_swap_b32 v20, v21
    v_permlane16_swap_b32 v22, v23
    s_nop 1
    v_add_f32 v16, v16, v17
    v_add_f32 v18, v18, v19
    v_add_f32 v20, v20, v21
    v_add_f32 v22, v22, v23
    s_nop 1
    v_permlane32_swap_b32 v16, v18
    v_permlane32_swap_b32 v20, v22
    s_nop 1
    v_add_f32 v16, v16, v18
    v_add_f32 v20, v20, v22
    s_nop 1
    v_add_f32_dpp v16, v16, v16 quad_perm:[1,0,3,2] row_mask:0xf bank_mask:0xf
    v_add_f32_dpp v20, v20, v20 quad_perm:[1,0,3,2] row_mask:0xf bank_mask:0xf
    s_nop 0
    v_add_f32_dpp v16, v16, v16 quad_perm:[2,3,0,1] row_mask:0xf bank_mask:0xf
    v_add_f32_dpp v20, v20, v20 quad_perm:[2,3,0,1] row_mask:0xf bank_mask:0xf
    s_nop 0
    v_add_f32_dpp v16, v16, v16 row_ror:4 row_mask:0xf bank_mask:0xf
    v_add_f32_dpp v20, v20, v20 row_ror:4 row_mask:0xf bank_mask:0xf
    s_nop 0
    v_lshrrev_b32 v25, 4, v1
    v_and_b32 v26, 1, v25
    v_lshrrev_b32 v25, 1, v25
    v_lshl_add_u32 v26, v25, 1, v26
    v_lshlrev_b32 v26, 2, v26
    s_and_b32 s38, s29, 7
    s_lshl_b32 s38, s38, 9
    s_lshr_b32 s39, s29, 3
    s_lshl_b32 s39, s39, 5
    s_add_u32 s38, s38, s39
    v_add_u32 v26, s38, v26
    s_mov_b32 s38, 0x00010001
    s_mov_b32 s39, 0x00010001
    s_mov_b64 exec, s[38:39]
    global_store_dword v26, v16, s[24:25] sc0 sc1
    global_store_dword v26, v20, s[24:25] offset:16 sc0 sc1
    s_mov_b64 exec, -1
a_noemb:
    s_cmp_eq_u32 s33, 0
    s_cbranch_scc0 a_nw0
    v_and_b32 v16, 15, v1
    v_lshlrev_b32 v16, 3, v16
    v_add_u32 v16, 100416, v16
    ds_read_b64 v[4:5], v16
    s_waitcnt lgkmcnt(0)
    v_add_f32_dpp v4, v4, v4 quad_perm:[2,3,0,1] row_mask:0xf bank_mask:0xf
    v_add_f32_dpp v5, v5, v5 quad_perm:[2,3,0,1] row_mask:0xf bank_mask:0xf
    s_nop 0
    v_add_f32_dpp v4, v4, v4 row_ror:4 row_mask:0xf bank_mask:0xf
    v_add_f32_dpp v5, v5, v5 row_ror:4 row_mask:0xf bank_mask:0xf
    s_nop 0
    v_add_f32_dpp v4, v4, v4 row_ror:8 row_mask:0xf bank_mask:0xf
    v_add_f32_dpp v5, v5, v5 row_ror:8 row_mask:0xf bank_mask:0xf
    s_nop 0
    s_mul_i32 s34, s34, 0x9e3779b1
    s_add_u32 s34, s34, 0x7f4a7c15
a_nw0:
    s_waitcnt vmcnt(0)
    s_barrier
    s_cmp_eq_u32 s33, 0
    s_cbranch_scc0 a_nw0b
    s_mov_b64 exec, 3
    v_mov_b32 v20, v4
    v_mov_b32 v21, v5
    v_mov_b32 v22, s34
    v_mov_b32 v23, 0
    v_lshlrev_b32 v16, 4, v1
    global_store_dwordx4 v16, v[20:23], s[94:95] sc0 sc1
    s_nop 1
    s_mov_b64 exec, -1
a_nw0b:
    s_lshl_b32 s38, s31, 2
    s_sub_u32 s38, s38, 1
    s_lshl_b32 s39, s32, 4
    s_sub_u32 s39, s39, 1
    v_mov_b32 v16, 0
    v_mov_b32 v17, 0
    v_mov_b32 v18, 0
    v_mov_b32 v19, 0
    v_lshrrev_b32 v23, 3, v0
    v_mov_b32 v68, 0
    v_mov_b32 v69, 0
    v_add_u32 v24, 0, v23
    v_min_u32 v24, 107, v24
    v_mul_u32_u24 v25, 3641, v24
    v_lshrrev_b32 v25, 16, v25
    v_mul_u32_u24 v26, 18, v25
    v_sub_u32 v26, v24, v26
    v_mul_u32_u24 v27, 5120, v25
    v_mad_u32_u24 v27, v26, s60, v27
    v_add_u32 v12, v27, v6
    v_add_u32 v25, s38, v25
    v_add_u32 v26, s39, v26
    v_cmp_gt_u32 vcc, 64, v25
    v_cmp_gt_u32 s[44:45], 64, v26
    v_med3_i32 v25, v25, 0, 63
    v_med3_i32 v26, v26, 0, 63
    s_and_b64 s[44:45], s[44:45], vcc
    v_lshl_add_u32 v25, v25, 6, v26
    v_lshl_add_u32 v8, v25, 8, v6
    s_not_b64 exec, s[44:45]
    ds_write_b128 v12, v[16:19]
    s_mov_b64 exec, -1

    v_add_u32 v24, 64, v23
    v_min_u32 v24, 107, v24
    v_mul_u32_u24 v25, 3641, v24
    v_lshrrev_b32 v25, 16, v25
    v_mul_u32_u24 v26, 18, v25
    v_sub_u32 v26, v24, v26
    v_mul_u32_u24 v27, 5120, v25
    v_mad_u32_u24 v27, v26, s60, v27
    v_add_u32 v13, v27, v6
    v_add_u32 v25, s38, v25
    v_add_u32 v26, s39, v26
    v_cmp_gt_u32 vcc, 64, v25
    v_cmp_gt_u32 s[46:47], 64, v26
    v_med3_i32 v25, v25, 0, 63
    v_med3_i32 v26, v26, 0, 63
    s_and_b64 s[46:47], s[46:47], vcc
    v_lshl_add_u32 v25, v25, 6, v26
    v_lshl_add_u32 v9, v25, 8, v6
    s_not_b64 exec, s[46:47]
    ds_write_b128 v13, v[16:19]
    s_mov_b64 exec, -1

    s_cmp_lt_u32 s33, 4
    s_cbranch_scc1 geo_done
    v_and_b32 v23, 31, v23
    v_add_u32 v7, 128, v6
    v_add_u32 v24, 0, v23
    v_min_u32 v24, 107, v24
    v_mul_u32_u24 v25, 3641, v24
    v_lshrrev_b32 v25, 16, v25
    v_mul_u32_u24 v26, 18, v25
    v_sub_u32 v26, v24, v26
    v_mul_u32_u24 v27, 5120, v25
    v_mad_u32_u24 v27, v26, s60, v27
    v_add_u32 v14, v27, v7
    v_add_u32 v25, s38, v25
    v_add_u32 v26, s39, v26
    v_cmp_gt_u32 vcc, 64, v25
    v_cmp_gt_u32 s[48:49], 64, v26
    v_med3_i32 v25, v25, 0, 63
    v_med3_i32 v26, v26, 0, 63
    s_and_b64 s[48:49], s[48:49], vcc
    v_lshl_add_u32 v25, v25, 6, v26
    v_lshl_add_u32 v10, v25, 8, v7
    s_not_b64 exec, s[48:49]
    ds_write_b128 v14, v[16:19]
    s_mov_b64 exec, -1

    v_add_u32 v24, 32, v23
    v_min_u32 v24, 107, v24
    v_mul_u32_u24 v25, 3641, v24
    v_lshrrev_b32 v25, 16, v25
    v_mul_u32_u24 v26, 18, v25
    v_sub_u32 v26, v24, v26
    v_mul_u32_u24 v27, 5120, v25
    v_mad_u32_u24 v27, v26, s60, v27
    v_add_u32 v15, v27, v7
    v_add_u32 v25, s38, v25
    v_add_u32 v26, s39, v26
    v_cmp_gt_u32 vcc, 64, v25
    v_cmp_gt_u32 s[50:51], 64, v26
    v_med3_i32 v25, v25, 0, 63
    v_med3_i32 v26, v26, 0, 63
    s_and_b64 s[50:51], s[50:51], vcc
    v_lshl_add_u32 v25, v25, 6, v26
    v_lshl_add_u32 v11, v25, 8, v7
    s_not_b64 exec, s[50:51]
    ds_write_b128 v15, v[16:19]
    s_mov_b64 exec, -1

    v_add_u32 v24, 64, v23
    v_min_u32 v24, 107, v24
    v_mul_u32_u24 v25, 3641, v24
    v_lshrrev_b32 v25, 16, v25
    v_mul_u32_u24 v26, 18, v25
    v_sub_u32 v26, v24, v26
    v_mul_u32_u24 v27, 5120, v25
    v_mad_u32_u24 v27, v26, s60, v27
    v_add_u32 v70, v27, v7
    v_add_u32 v25, s38, v25
    v_add_u32 v26, s39, v26
    v_cmp_gt_u32 vcc, 64, v25
    v_cmp_gt_u32 s[52:53], 64, v26
    v_med3_i32 v25, v25, 0, 63
    v_med3_i32 v26, v26, 0, 63
    s_and_b64 s[52:53], s[52:53], vcc
    v_lshl_add_u32 v25, v25, 6, v26
    v_lshl_add_u32 v68, v25, 8, v7
    s_not_b64 exec, s[52:53]
    ds_write_b128 v70, v[16:19]
    s_mov_b64 exec, -1

    v_add_u32 v24, 96, v23
    v_min_u32 v24, 107, v24
    v_mul_u32_u24 v25, 3641, v24
    v_lshrrev_b32 v25, 16, v25
    v_mul_u32_u24 v26, 18, v25
    v_sub_u32 v26, v24, v26
    v_mul_u32_u24 v27, 5120, v25
    v_mad_u32_u24 v27, v26, s60, v27
    v_add_u32 v71, v27, v7
    v_add_u32 v25, s38, v25
    v_add_u32 v26, s39, v26
    v_cmp_gt_u32 vcc, 64, v25
    v_cmp_gt_u32 s[54:55], 64, v26
    v_med3_i32 v25, v25, 0, 63
    v_med3_i32 v26, v26, 0, 63
    s_and_b64 s[54:55], s[54:55], vcc
    v_lshl_add_u32 v25, v25, 6, v26
    v_lshl_add_u32 v69, v25, 8, v7
    s_not_b64 exec, s[54:55]
    ds_write_b128 v71, v[16:19]
    s_mov_b64 exec, -1

geo_done:
    s_cmp_eq_u32 s33, 0
    s_cbranch_scc0 p1_skip
    v_lshlrev_b32 v16, 4, v1
    s_mov_b32 s40, 0x20000
    global_load_dwordx4 v[200:203], v16, s[90:91] offset:0 sc1
    global_load_dwordx4 v[204:207], v16, s[90:91] offset:1024 sc1
    global_load_dwordx4 v[208:211], v16, s[90:91] offset:2048 sc1
    global_load_dwordx4 v[212:215], v16, s[90:91] offset:3072 sc1
p1_loop:
    s_waitcnt vmcnt(0)
    v_cmp_eq_u32 vcc, s34, v202
    v_cmp_eq_u32 s[42:43], s34, v206
    v_cmp_eq_u32 s[52:53], s34, v210
    v_cmp_eq_u32 s[54:55], s34, v214
    s_nop 1
    s_and_b64 vcc, vcc, s[42:43]
    s_and_b64 s[52:53], s[52:53], s[54:55]
    s_and_b64 vcc, vcc, s[52:53]
    s_cmp_eq_u64 vcc, -1
    s_cbranch_scc1 p1_x0
    s_sleep 8
    global_load_dwordx4 v[200:203], v16, s[90:91] offset:0 sc1
    global_load_dwordx4 v[204:207], v16, s[90:91] offset:1024 sc1
    global_load_dwordx4 v[208:211], v16, s[90:91] offset:2048 sc1
    global_load_dwordx4 v[212:215], v16, s[90:91] offset:3072 sc1
    s_sub_u32 s40, s40, 1
    s_cmp_lg_u32 s40, 0
    s_cbranch_scc1 p1_loop
    s_waitcnt vmcnt(0)
p1_x0:
    v_add_f32 v32, v200, v204
    v_add_f32 v33, v201, v205
    v_add_f32 v40, v208, v212
    v_add_f32 v41, v209, v213
p1_done:
p1_skip:
    s_waitcnt lgkmcnt(0)
    s_barrier
    s_and_b32 s38, s33, 1
    s_lshl_b32 s39, s30, 1
    s_add_u32 s38, s38, s39
    s_lshl_b32 s38, s38, 2
    s_lshr_b32 s39, s33, 1
    s_add_u32 s38, s38, s39
    s_mul_i32 s38, s38, 18432
    v_lshlrev_b32 v64, 4, v1
    v_add_u32 v64, s38, v64
    v_add_u32 v65, 294912, v64
    s_cmp_eq_u32 s33, 3
    s_cbranch_scc0 tl0_ne
    v_lshlrev_b32 v16, 2, v1
    s_lshl_b32 s38, s30, 8
    v_add_u32 v16, s38, v16
    global_load_dword v216, v16, s[24:25] offset:0 sc1
    global_load_dword v217, v16, s[24:25] offset:512 sc1
    global_load_dword v218, v16, s[24:25] offset:1024 sc1
    global_load_dword v219, v16, s[24:25] offset:1536 sc1
    global_load_dword v220, v16, s[24:25] offset:2048 sc1
    global_load_dword v221, v16, s[24:25] offset:2560 sc1
    global_load_dword v222, v16, s[24:25] offset:3072 sc1
    global_load_dword v223, v16, s[24:25] offset:3584 sc1
tl0_ne:
    global_load_dwordx4 v[48:51], v8, s[88:89] sc1
    global_load_dwordx4 v[52:55], v9, s[88:89] sc1
    s_cmp_lt_u32 s33, 4
    s_cbranch_scc1 tl0_l
    global_load_dwordx4 v[80:83], v10, s[88:89] sc1
    global_load_dwordx4 v[84:87], v11, s[88:89] sc1
    global_load_dwordx4 v[88:91], v68, s[88:89] sc1
    global_load_dwordx4 v[92:95], v69, s[88:89] sc1
    s_branch tl0_e
tl0_l:
tl0_e:
    s_cmp_eq_u32 s33, 0
    s_cbranch_scc0 s1_nw0
    v_add_f32 v32, v32, v40
    v_add_f32 v33, v33, v41
    s_nop 1
    v_add_f32_dpp v32, v32, v32 row_ror:8 row_mask:0xf bank_mask:0xf
    v_add_f32_dpp v33, v33, v33 row_ror:8 row_mask:0xf bank_mask:0xf
    s_nop 0
    v_add_f32_dpp v32, v32, v32 row_ror:4 row_mask:0xf bank_mask:0xf
    v_add_f32_dpp v33, v33, v33 row_ror:4 row_mask:0xf bank_mask:0xf
    s_nop 0
    v_mov_b32 v34, v32
    v_mov_b32 v35, v33
    s_nop 1
    v_permlane16_swap_b32 v32, v34
    v_permlane16_swap_b32 v33, v35
    s_nop 1
    v_add_f32 v32, v32, v34
    v_add_f32 v33, v33, v35
    s_nop 1
    v_mov_b32 v34, v32
    v_mov_b32 v35, v33
    s_nop 1
    v_permlane32_swap_b32 v32, v34
    v_permlane32_swap_b32 v33, v35
    s_nop 1
    v_add_f32 v32, v32, v34
    v_add_f32 v33, v33, v35
    s_nop 1
    v_mul_f32 v32, 0x37000000, v32
    v_mul_f32 v33, 0x37000000, v33
    v_fma_f32 v33, -v32, v32, v33
    v_max_f32 v33, 0, v33
    v_add_f32 v33, 0x3727c5ac, v33
    v_rsq_f32 v33, v33
    v_lshlrev_b32 v34, 3, v1
    v_add_u32 v34, 100352, v34
    s_mov_b64 exec, 15
    ds_write_b64 v34, v[32:33]
    s_mov_b64 exec, -1
    s_cmp_eq_u32 s29, 0
    s_cbranch_scc0 s1_nw0
    v_mov_b32 v16, s34
    v_mov_b32 v17, 0
    s_mov_b64 exec, 1
    global_store_dword v17, v16, s[62:63] sc0 sc1
    s_mov_b64 exec, -1
s1_nw0:
    s_waitcnt lgkmcnt(0)
    s_barrier
    v_bfe_u32 v16, v0, 2, 1
    v_lshlrev_b32 v16, 3, v16
    v_add_u32 v16, 100352, v16
    ds_read_b64 v[16:17], v16
    v_lshlrev_b32 v32, 16, v96
    v_and_b32 v33, 0xffff0000, v96
    v_lshlrev_b32 v40, 16, v100
    v_and_b32 v41, 0xffff0000, v100
    v_lshlrev_b32 v34, 16, v97
    v_and_b32 v35, 0xffff0000, v97
    v_lshlrev_b32 v42, 16, v101
    v_and_b32 v43, 0xffff0000, v101
    v_lshlrev_b32 v36, 16, v98
    v_and_b32 v37, 0xffff0000, v98
    v_lshlrev_b32 v44, 16, v102
    v_and_b32 v45, 0xffff0000, v102
    v_lshlrev_b32 v38, 16, v99
    v_and_b32 v39, 0xffff0000, v99
    v_lshlrev_b32 v46, 16, v103
    v_and_b32 v47, 0xffff0000, v103
    v_pk_mul_f32 v[40:41], v[40:41], s[56:57]
    v_pk_mul_f32 v[42:43], v[42:43], s[56:57]
    v_pk_mul_f32 v[44:45], v[44:45], s[56:57]
    v_pk_mul_f32 v[46:47], v[46:47], s[56:57]
    s_waitcnt lgkmcnt(0)
    v_mul_f32 v17, s56, v17
    s_nop 0
    v_pk_mul_f32 v[32:33], v[32:33], v[16:17] op_sel:[0,1] op_sel_hi:[1,1]
    v_pk_mul_f32 v[34:35], v[34:35], v[16:17] op_sel:[0,1] op_sel_hi:[1,1]
    v_pk_mul_f32 v[36:37], v[36:37], v[16:17] op_sel:[0,1] op_sel_hi:[1,1]
    v_pk_mul_f32 v[38:39], v[38:39], v[16:17] op_sel:[0,1] op_sel_hi:[1,1]
    v_pk_fma_f32 v[40:41], v[32:33], v[16:17], v[40:41] op_sel:[0,0,0] op_sel_hi:[1,0,1] neg_lo:[1,0,0] neg_hi:[1,0,0]
    v_pk_fma_f32 v[42:43], v[34:35], v[16:17], v[42:43] op_sel:[0,0,0] op_sel_hi:[1,0,1] neg_lo:[1,0,0] neg_hi:[1,0,0]
    v_pk_fma_f32 v[44:45], v[36:37], v[16:17], v[44:45] op_sel:[0,0,0] op_sel_hi:[1,0,1] neg_lo:[1,0,0] neg_hi:[1,0,0]
    v_pk_fma_f32 v[46:47], v[38:39], v[16:17], v[46:47] op_sel:[0,0,0] op_sel_hi:[1,0,1] neg_lo:[1,0,0] neg_hi:[1,0,0]
    s_cmp_lt_u32 s33, 4
    s_cbranch_scc1 c0_wl
    v_bfe_u32 v16, v0, 2, 1
    v_lshlrev_b32 v16, 3, v16
    v_add_u32 v16, 100368, v16
    ds_read_b64 v[16:17], v16
    v_lshlrev_b32 v200, 16, v104
    v_and_b32 v201, 0xffff0000, v104
    v_lshlrev_b32 v208, 16, v108
    v_and_b32 v209, 0xffff0000, v108
    v_lshlrev_b32 v202, 16, v105
    v_and_b32 v203, 0xffff0000, v105
    v_lshlrev_b32 v210, 16, v109
    v_and_b32 v211, 0xffff0000, v109
    v_lshlrev_b32 v204, 16, v106
    v_and_b32 v205, 0xffff0000, v106
    v_lshlrev_b32 v212, 16, v110
    v_and_b32 v213, 0xffff0000, v110
    v_lshlrev_b32 v206, 16, v107
    v_and_b32 v207, 0xffff0000, v107
    v_lshlrev_b32 v214, 16, v111
    v_and_b32 v215, 0xffff0000, v111
    v_pk_mul_f32 v[208:209], v[208:209], s[56:57]
    v_pk_mul_f32 v[210:211], v[210:211], s[56:57]
    v_pk_mul_f32 v[212:213], v[212:213], s[56:57]
    v_pk_mul_f32 v[214:215], v[214:215], s[56:57]
    s_waitcnt lgkmcnt(0)
    v_mul_f32 v17, s56, v17
    s_nop 0
    v_pk_mul_f32 v[200:201], v[200:201], v[16:17] op_sel:[0,1] op_sel_hi:[1,1]
    v_pk_mul_f32 v[202:203], v[202:203], v[16:17] op_sel:[0,1] op_sel_hi:[1,1]
    v_pk_mul_f32 v[204:205], v[204:205], v[16:17] op_sel:[0,1] op_sel_hi:[1,1]
    v_pk_mul_f32 v[206:207], v[206:207], v[16:17] op_sel:[0,1] op_sel_hi:[1,1]
    v_pk_fma_f32 v[208:209], v[200:201], v[16:17], v[208:209] op_sel:[0,0,0] op_sel_hi:[1,0,1] neg_lo:[1,0,0] neg_hi:[1,0,0]
    v_pk_fma_f32 v[210:211], v[202:203], v[16:17], v[210:211] op_sel:[0,0,0] op_sel_hi:[1,0,1] neg_lo:[1,0,0] neg_hi:[1,0,0]
    v_pk_fma_f32 v[212:213], v[204:205], v[16:17], v[212:213] op_sel:[0,0,0] op_sel_hi:[1,0,1] neg_lo:[1,0,0] neg_hi:[1,0,0]
    v_pk_fma_f32 v[214:215], v[206:207], v[16:17], v[214:215] op_sel:[0,0,0] op_sel_hi:[1,0,1] neg_lo:[1,0,0] neg_hi:[1,0,0]
    s_waitcnt vmcnt(4)
    v_lshlrev_b32 v16, 16, v48
    v_and_b32 v17, 0xffff0000, v48
    v_lshlrev_b32 v18, 16, v49
    v_and_b32 v19, 0xffff0000, v49
    v_lshlrev_b32 v20, 16, v50
    v_and_b32 v21, 0xffff0000, v50
    v_lshlrev_b32 v22, 16, v51
    v_and_b32 v23, 0xffff0000, v51
    v_pk_fma_f32 v[16:17], v[16:17], v[32:33], v[40:41]
    v_pk_fma_f32 v[18:19], v[18:19], v[34:35], v[42:43]
    v_pk_fma_f32 v[20:21], v[20:21], v[36:37], v[44:45]
    v_pk_fma_f32 v[22:23], v[22:23], v[38:39], v[46:47]
    v_exp_f32 v24, v16
    v_exp_f32 v25, v17
    v_exp_f32 v26, v18
    v_exp_f32 v27, v19
    v_exp_f32 v28, v20
    v_exp_f32 v29, v21
    v_exp_f32 v30, v22
    v_exp_f32 v31, v23
    v_pk_fma_f32 v[24:25], v[24:25], s[56:57], s[56:57]
    v_pk_fma_f32 v[26:27], v[26:27], s[56:57], s[56:57]
    v_pk_fma_f32 v[28:29], v[28:29], s[56:57], s[56:57]
    v_pk_fma_f32 v[30:31], v[30:31], s[56:57], s[56:57]
    v_rcp_f32 v24, v24
    v_lshlrev_b32 v184, 16, v52
    v_rcp_f32 v25, v25
    v_and_b32 v185, 0xffff0000, v52
    v_lshlrev_b32 v186, 16, v53
    v_rcp_f32 v26, v26
    v_and_b32 v187, 0xffff0000, v53
    v_rcp_f32 v27, v27
    v_lshlrev_b32 v188, 16, v54
    v_and_b32 v189, 0xffff0000, v54
    v_rcp_f32 v28, v28
    v_lshlrev_b32 v190, 16, v55
    v_rcp_f32 v29, v29
    v_and_b32 v191, 0xffff0000, v55
    v_pk_fma_f32 v[184:185], v[184:185], v[32:33], v[40:41]
    v_rcp_f32 v30, v30
    v_pk_fma_f32 v[186:187], v[186:187], v[34:35], v[42:43]
    v_rcp_f32 v31, v31
    v_pk_fma_f32 v[188:189], v[188:189], v[36:37], v[44:45]
    v_pk_fma_f32 v[190:191], v[190:191], v[38:39], v[46:47]
    v_exp_f32 v192, v184
    v_pk_mul_f32 v[16:17], v[16:17], v[24:25]
    v_exp_f32 v193, v185
    v_pk_mul_f32 v[18:19], v[18:19], v[26:27]
    v_exp_f32 v194, v186
    v_pk_mul_f32 v[20:21], v[20:21], v[28:29]
    v_exp_f32 v195, v187
    v_pk_mul_f32 v[22:23], v[22:23], v[30:31]
    v_exp_f32 v196, v188
    v_cvt_pk_bf16_f32 v24, v16, v17
    v_exp_f32 v197, v189
    v_cvt_pk_bf16_f32 v25, v18, v19
    v_exp_f32 v198, v190
    v_cvt_pk_bf16_f32 v26, v20, v21
    v_exp_f32 v199, v191
    v_cvt_pk_bf16_f32 v27, v22, v23
    s_mov_b64 exec, s[44:45]
    ds_write_b128 v12, v[24:27]
    s_mov_b64 exec, -1
    v_pk_fma_f32 v[192:193], v[192:193], s[56:57], s[56:57]
    v_pk_fma_f32 v[194:195], v[194:195], s[56:57], s[56:57]
    v_pk_fma_f32 v[196:197], v[196:197], s[56:57], s[56:57]
    v_pk_fma_f32 v[198:199], v[198:199], s[56:57], s[56:57]
    v_rcp_f32 v192, v192
    v_rcp_f32 v193, v193
    v_rcp_f32 v194, v194
    v_rcp_f32 v195, v195
    v_rcp_f32 v196, v196
    v_rcp_f32 v197, v197
    v_rcp_f32 v198, v198
    v_rcp_f32 v199, v199
    s_nop 0
    v_pk_mul_f32 v[184:185], v[184:185], v[192:193]
    v_pk_mul_f32 v[186:187], v[186:187], v[194:195]
    v_pk_mul_f32 v[188:189], v[188:189], v[196:197]
    v_pk_mul_f32 v[190:191], v[190:191], v[198:199]
    v_cvt_pk_bf16_f32 v192, v184, v185
    v_cvt_pk_bf16_f32 v193, v186, v187
    v_cvt_pk_bf16_f32 v194, v188, v189
    v_cvt_pk_bf16_f32 v195, v190, v191
    s_mov_b64 exec, s[46:47]
    ds_write_b128 v13, v[192:195]
    s_mov_b64 exec, -1
    s_waitcnt vmcnt(3)
    v_lshlrev_b32 v16, 16, v80
    v_and_b32 v17, 0xffff0000, v80
    v_lshlrev_b32 v18, 16, v81
    v_and_b32 v19, 0xffff0000, v81
    v_lshlrev_b32 v20, 16, v82
    v_and_b32 v21, 0xffff0000, v82
    v_lshlrev_b32 v22, 16, v83
    v_and_b32 v23, 0xffff0000, v83
    v_pk_fma_f32 v[16:17], v[16:17], v[200:201], v[208:209]
    v_pk_fma_f32 v[18:19], v[18:19], v[202:203], v[210:211]
    v_pk_fma_f32 v[20:21], v[20:21], v[204:205], v[212:213]
    v_pk_fma_f32 v[22:23], v[22:23], v[206:207], v[214:215]
    v_exp_f32 v24, v16
    v_exp_f32 v25, v17
    v_exp_f32 v26, v18
    v_exp_f32 v27, v19
    v_exp_f32 v28, v20
    v_exp_f32 v29, v21
    v_exp_f32 v30, v22
    v_exp_f32 v31, v23
    v_pk_fma_f32 v[24:25], v[24:25], s[56:57], s[56:57]
    v_pk_fma_f32 v[26:27], v[26:27], s[56:57], s[56:57]
    v_pk_fma_f32 v[28:29], v[28:29], s[56:57], s[56:57]
    v_pk_fma_f32 v[30:31], v[30:31], s[56:57], s[56:57]
    v_rcp_f32 v24, v24
    v_rcp_f32 v25, v25
    v_rcp_f32 v26, v26
    v_rcp_f32 v27, v27
    v_rcp_f32 v28, v28
    v_rcp_f32 v29, v29
    v_rcp_f32 v30, v30
    v_rcp_f32 v31, v31
    s_nop 0
    v_pk_mul_f32 v[16:17], v[16:17], v[24:25]
    v_pk_mul_f32 v[18:19], v[18:19], v[26:27]
    v_pk_mul_f32 v[20:21], v[20:21], v[28:29]
    v_pk_mul_f32 v[22:23], v[22:23], v[30:31]
    v_cvt_pk_bf16_f32 v24, v16, v17
    v_cvt_pk_bf16_f32 v25, v18, v19
    v_cvt_pk_bf16_f32 v26, v20, v21
    v_cvt_pk_bf16_f32 v27, v22, v23
    s_mov_b64 exec, s[48:49]
    ds_write_b128 v14, v[24:27]
    s_mov_b64 exec, -1
    s_branch c0_w
c0_wl:
    s_waitcnt vmcnt(0)
    global_load_dwordx4 v[112:115], v64, s[100:101] offset:0 sc1
    v_lshlrev_b32 v16, 16, v48
    v_and_b32 v17, 0xffff0000, v48
    v_lshlrev_b32 v18, 16, v49
    v_and_b32 v19, 0xffff0000, v49
    global_load_dwordx4 v[116:119], v64, s[100:101] offset:1024 sc1
    v_lshlrev_b32 v20, 16, v50
    v_and_b32 v21, 0xffff0000, v50
    v_lshlrev_b32 v22, 16, v51
    v_and_b32 v23, 0xffff0000, v51
    global_load_dwordx4 v[120:123], v64, s[100:101] offset:2048 sc1
    v_pk_fma_f32 v[16:17], v[16:17], v[32:33], v[40:41]
    v_pk_fma_f32 v[18:19], v[18:19], v[34:35], v[42:43]
    v_pk_fma_f32 v[20:21], v[20:21], v[36:37], v[44:45]
    v_pk_fma_f32 v[22:23], v[22:23], v[38:39], v[46:47]
    global_load_dwordx4 v[124:127], v64, s[100:101] offset:3072 sc1
    v_add_u32 v64, 4096, v64
    v_exp_f32 v24, v16
    v_exp_f32 v25, v17
    v_exp_f32 v26, v18
    v_exp_f32 v27, v19
    global_load_dwordx4 v[128:131], v64, s[100:101] offset:0 sc1
    v_exp_f32 v28, v20
    v_exp_f32 v29, v21
    v_exp_f32 v30, v22
    v_exp_f32 v31, v23
    global_load_dwordx4 v[132:135], v64, s[100:101] offset:1024 sc1
    v_pk_fma_f32 v[24:25], v[24:25], s[56:57], s[56:57]
    v_pk_fma_f32 v[26:27], v[26:27], s[56:57], s[56:57]
    v_pk_fma_f32 v[28:29], v[28:29], s[56:57], s[56:57]
    v_pk_fma_f32 v[30:31], v[30:31], s[56:57], s[56:57]
    global_load_dwordx4 v[136:139], v64, s[100:101] offset:2048 sc1
    v_rcp_f32 v24, v24
    v_lshlrev_b32 v184, 16, v52
    v_rcp_f32 v25, v25
    v_and_b32 v185, 0xffff0000, v52
    global_load_dwordx4 v[140:143], v64, s[100:101] offset:3072 sc1
    v_add_u32 v64, 4096, v64
    v_lshlrev_b32 v186, 16, v53
    v_rcp_f32 v26, v26
    v_and_b32 v187, 0xffff0000, v53
    v_rcp_f32 v27, v27
    global_load_dwordx4 v[144:147], v64, s[100:101] offset:0 sc1
    v_lshlrev_b32 v188, 16, v54
    v_and_b32 v189, 0xffff0000, v54
    v_rcp_f32 v28, v28
    v_lshlrev_b32 v190, 16, v55
    global_load_dwordx4 v[148:151], v64, s[100:101] offset:1024 sc1
    v_rcp_f32 v29, v29
    v_and_b32 v191, 0xffff0000, v55
    v_pk_fma_f32 v[184:185], v[184:185], v[32:33], v[40:41]
    v_rcp_f32 v30, v30
    global_load_dwordx4 v[152:155], v64, s[100:101] offset:2048 sc1
    v_pk_fma_f32 v[186:187], v[186:187], v[34:35], v[42:43]
    v_rcp_f32 v31, v31
    v_pk_fma_f32 v[188:189], v[188:189], v[36:37], v[44:45]
    v_pk_fma_f32 v[190:191], v[190:191], v[38:39], v[46:47]
    global_load_dwordx4 v[156:159], v64, s[100:101] offset:3072 sc1
    v_add_u32 v64, 4096, v64
    v_exp_f32 v192, v184
    v_pk_mul_f32 v[16:17], v[16:17], v[24:25]
    v_exp_f32 v193, v185
    v_pk_mul_f32 v[18:19], v[18:19], v[26:27]
    global_load_dwordx4 v[160:163], v64, s[100:101] offset:0 sc1
    v_exp_f32 v194, v186
    v_pk_mul_f32 v[20:21], v[20:21], v[28:29]
    v_exp_f32 v195, v187
    v_pk_mul_f32 v[22:23], v[22:23], v[30:31]
    global_load_dwordx4 v[164:167], v64, s[100:101] offset:1024 sc1
    v_exp_f32 v196, v188
    v_cvt_pk_bf16_f32 v24, v16, v17
    v_exp_f32 v197, v189
    v_cvt_pk_bf16_f32 v25, v18, v19
    global_load_dwordx4 v[168:171], v64, s[100:101] offset:2048 sc1
    v_exp_f32 v198, v190
    v_cvt_pk_bf16_f32 v26, v20, v21
    v_exp_f32 v199, v191
    v_cvt_pk_bf16_f32 v27, v22, v23
    global_load_dwordx4 v[172:175], v64, s[100:101] offset:3072 sc1
    v_add_u32 v64, 4096, v64
    s_mov_b64 exec, s[44:45]
    ds_write_b128 v12, v[24:27]
    s_mov_b64 exec, -1
    v_pk_fma_f32 v[192:193], v[192:193], s[56:57], s[56:57]
    global_load_dwordx4 v[176:179], v64, s[100:101] offset:0 sc1
    v_pk_fma_f32 v[194:195], v[194:195], s[56:57], s[56:57]
    v_pk_fma_f32 v[196:197], v[196:197], s[56:57], s[56:57]
    v_pk_fma_f32 v[198:199], v[198:199], s[56:57], s[56:57]
    v_rcp_f32 v192, v192
    global_load_dwordx4 v[180:183], v64, s[100:101] offset:1024 sc1
    v_rcp_f32 v193, v193
    v_rcp_f32 v194, v194
    v_rcp_f32 v195, v195
    v_rcp_f32 v196, v196
    v_rcp_f32 v197, v197
    v_rcp_f32 v198, v198
    v_rcp_f32 v199, v199
    s_nop 0
    v_pk_mul_f32 v[184:185], v[184:185], v[192:193]
    v_pk_mul_f32 v[186:187], v[186:187], v[194:195]
    v_pk_mul_f32 v[188:189], v[188:189], v[196:197]
    v_pk_mul_f32 v[190:191], v[190:191], v[198:199]
    v_cvt_pk_bf16_f32 v192, v184, v185
    v_cvt_pk_bf16_f32 v193, v186, v187
    v_cvt_pk_bf16_f32 v194, v188, v189
    v_cvt_pk_bf16_f32 v195, v190, v191
    s_mov_b64 exec, s[46:47]
    ds_write_b128 v13, v[192:195]
    s_mov_b64 exec, -1
c0_w:
    v_bfe_u32 v2, v1, 4, 1
    v_mul_u32_u24 v2, 5120, v2
    v_and_b32 v17, 15, v1
    v_mad_u32_u24 v2, v17, s60, v2
    v_lshrrev_b32 v17, 5, v1
    v_lshl_add_u32 v2, v17, 4, v2
    s_lshr_b32 s42, s33, 1
    s_lshl_b32 s42, s42, 6
    v_add_u32 v2, s42, v2
    v_and_b32 v18, 31, v1
    v_mul_u32_u24 v3, 272, v18
    v_lshl_add_u32 v3, v17, 4, v3
    s_lshr_b32 s42, s33, 1
    s_mul_i32 s42, s42, 17408
    s_and_b32 s43, s33, 1
    s_lshl_b32 s43, s43, 7
    s_add_u32 s42, s42, s43
    s_add_u32 s42, s42, 30720
    v_add_u32 v3, s42, v3
    s_waitcnt lgkmcnt(0)
    s_barrier
    s_cmp_lt_u32 s33, 4
    s_cbranch_scc1 c0_mf
    s_waitcnt vmcnt(0)
    global_load_dwordx4 v[112:115], v64, s[100:101] offset:0 sc1
    v_lshlrev_b32 v16, 16, v84
    v_and_b32 v17, 0xffff0000, v84
    v_lshlrev_b32 v18, 16, v85
    v_and_b32 v19, 0xffff0000, v85
    v_lshlrev_b32 v20, 16, v86
    v_and_b32 v21, 0xffff0000, v86
    v_lshlrev_b32 v22, 16, v87
    v_and_b32 v23, 0xffff0000, v87
    global_load_dwordx4 v[116:119], v64, s[100:101] offset:1024 sc1
    v_fma_f32 v16, v16, v200, v208
    v_fma_f32 v17, v17, v201, v209
    v_fma_f32 v18, v18, v202, v210
    v_fma_f32 v19, v19, v203, v211
    v_fma_f32 v20, v20, v204, v212
    v_fma_f32 v21, v21, v205, v213
    v_fma_f32 v22, v22, v206, v214
    v_fma_f32 v23, v23, v207, v215
    global_load_dwordx4 v[120:123], v64, s[100:101] offset:2048 sc1
    v_exp_f32 v24, v16
    v_exp_f32 v25, v17
    v_exp_f32 v26, v18
    v_exp_f32 v27, v19
    v_exp_f32 v28, v20
    v_exp_f32 v29, v21
    v_exp_f32 v30, v22
    v_exp_f32 v31, v23
    global_load_dwordx4 v[124:127], v64, s[100:101] offset:3072 sc1
    v_add_u32 v64, 4096, v64
    v_fma_f32 v24, v24, s56, s56
    v_fma_f32 v25, v25, s56, s56
    v_fma_f32 v26, v26, s56, s56
    v_fma_f32 v27, v27, s56, s56
    v_fma_f32 v28, v28, s56, s56
    v_fma_f32 v29, v29, s56, s56
    v_fma_f32 v30, v30, s56, s56
    v_fma_f32 v31, v31, s56, s56
    global_load_dwordx4 v[128:131], v64, s[100:101] offset:0 sc1
    v_rcp_f32 v24, v24
    v_lshlrev_b32 v48, 16, v88
    v_and_b32 v49, 0xffff0000, v88
    v_rcp_f32 v25, v25
    v_lshlrev_b32 v50, 16, v89
    v_and_b32 v51, 0xffff0000, v89
    v_rcp_f32 v26, v26
    v_lshlrev_b32 v52, 16, v90
    global_load_dwordx4 v[132:135], v64, s[100:101] offset:1024 sc1
    v_and_b32 v53, 0xffff0000, v90
    v_rcp_f32 v27, v27
    v_lshlrev_b32 v54, 16, v91
    v_and_b32 v55, 0xffff0000, v91
    v_rcp_f32 v28, v28
    v_fma_f32 v48, v48, v200, v208
    v_fma_f32 v49, v49, v201, v209
    v_rcp_f32 v29, v29
    global_load_dwordx4 v[136:139], v64, s[100:101] offset:2048 sc1
    v_fma_f32 v50, v50, v202, v210
    v_fma_f32 v51, v51, v203, v211
    v_rcp_f32 v30, v30
    v_fma_f32 v52, v52, v204, v212
    v_fma_f32 v53, v53, v205, v213
    v_rcp_f32 v31, v31
    v_fma_f32 v54, v54, v206, v214
    v_fma_f32 v55, v55, v207, v215
    global_load_dwordx4 v[140:143], v64, s[100:101] offset:3072 sc1
    v_add_u32 v64, 4096, v64
    v_exp_f32 v56, v48
    v_mul_f32 v16, v16, v24
    v_exp_f32 v57, v49
    v_mul_f32 v17, v17, v25
    v_mul_f32 v18, v18, v26
    v_exp_f32 v58, v50
    v_mul_f32 v19, v19, v27
    v_exp_f32 v59, v51
    global_load_dwordx4 v[144:147], v64, s[100:101] offset:0 sc1
    v_mul_f32 v20, v20, v28
    v_mul_f32 v21, v21, v29
    v_exp_f32 v60, v52
    v_mul_f32 v22, v22, v30
    v_exp_f32 v61, v53
    v_mul_f32 v23, v23, v31
    v_cvt_pk_bf16_f32 v24, v16, v17
    v_exp_f32 v62, v54
    global_load_dwordx4 v[148:151], v64, s[100:101] offset:1024 sc1
    v_cvt_pk_bf16_f32 v25, v18, v19
    v_exp_f32 v63, v55
    v_cvt_pk_bf16_f32 v26, v20, v21
    v_cvt_pk_bf16_f32 v27, v22, v23
    s_mov_b64 exec, s[50:51]
    ds_write_b128 v15, v[24:27]
    s_mov_b64 exec, -1
    v_fma_f32 v56, v56, s56, s56
    global_load_dwordx4 v[152:155], v64, s[100:101] offset:2048 sc1
    v_fma_f32 v57, v57, s56, s56
    v_fma_f32 v58, v58, s56, s56
    v_fma_f32 v59, v59, s56, s56
    v_fma_f32 v60, v60, s56, s56
    v_fma_f32 v61, v61, s56, s56
    v_fma_f32 v62, v62, s56, s56
    v_fma_f32 v63, v63, s56, s56
    v_rcp_f32 v56, v56
    global_load_dwordx4 v[156:159], v64, s[100:101] offset:3072 sc1
    v_add_u32 v64, 4096, v64
    v_lshlrev_b32 v16, 16, v92
    v_and_b32 v17, 0xffff0000, v92
    v_rcp_f32 v57, v57
    v_lshlrev_b32 v18, 16, v93
    v_and_b32 v19, 0xffff0000, v93
    v_rcp_f32 v58, v58
    v_lshlrev_b32 v20, 16, v94
    v_and_b32 v21, 0xffff0000, v94
    global_load_dwordx4 v[160:163], v64, s[100:101] offset:0 sc1
    v_rcp_f32 v59, v59
    v_lshlrev_b32 v22, 16, v95
    v_and_b32 v23, 0xffff0000, v95
    v_rcp_f32 v60, v60
    v_fma_f32 v16, v16, v200, v208
    v_fma_f32 v17, v17, v201, v209
    v_rcp_f32 v61, v61
    v_fma_f32 v18, v18, v202, v210
    global_load_dwordx4 v[164:167], v64, s[100:101] offset:1024 sc1
    v_fma_f32 v19, v19, v203, v211
    v_rcp_f32 v62, v62
    v_fma_f32 v20, v20, v204, v212
    v_fma_f32 v21, v21, v205, v213
    v_rcp_f32 v63, v63
    v_fma_f32 v22, v22, v206, v214
    v_fma_f32 v23, v23, v207, v215
    v_exp_f32 v24, v16
    global_load_dwordx4 v[168:171], v64, s[100:101] offset:2048 sc1
    v_mul_f32 v48, v48, v56
    v_exp_f32 v25, v17
    v_mul_f32 v49, v49, v57
    v_mul_f32 v50, v50, v58
    v_exp_f32 v26, v18
    v_mul_f32 v51, v51, v59
    v_exp_f32 v27, v19
    v_mul_f32 v52, v52, v60
    global_load_dwordx4 v[172:175], v64, s[100:101] offset:3072 sc1
    v_add_u32 v64, 4096, v64
    v_mul_f32 v53, v53, v61
    v_exp_f32 v28, v20
    v_mul_f32 v54, v54, v62
    v_exp_f32 v29, v21
    v_mul_f32 v55, v55, v63
    v_cvt_pk_bf16_f32 v56, v48, v49
    v_exp_f32 v30, v22
    v_cvt_pk_bf16_f32 v57, v50, v51
    global_load_dwordx4 v[176:179], v64, s[100:101] offset:0 sc1
    v_exp_f32 v31, v23
    v_cvt_pk_bf16_f32 v58, v52, v53
    v_cvt_pk_bf16_f32 v59, v54, v55
    s_mov_b64 exec, s[52:53]
    ds_write_b128 v70, v[56:59]
    s_mov_b64 exec, -1
    v_fma_f32 v24, v24, s56, s56
    v_fma_f32 v25, v25, s56, s56
    global_load_dwordx4 v[180:183], v64, s[100:101] offset:1024 sc1
    v_fma_f32 v26, v26, s56, s56
    v_fma_f32 v27, v27, s56, s56
    v_fma_f32 v28, v28, s56, s56
    v_fma_f32 v29, v29, s56, s56
    v_fma_f32 v30, v30, s56, s56
    v_fma_f32 v31, v31, s56, s56
    v_rcp_f32 v24, v24
    v_rcp_f32 v25, v25
    v_rcp_f32 v26, v26
    v_rcp_f32 v27, v27
    v_rcp_f32 v28, v28
    v_rcp_f32 v29, v29
    v_rcp_f32 v30, v30
    v_rcp_f32 v31, v31
    s_nop 0
    v_mul_f32 v16, v16, v24
    v_mul_f32 v17, v17, v25
    v_mul_f32 v18, v18, v26
    v_mul_f32 v19, v19, v27
    v_mul_f32 v20, v20, v28
    v_mul_f32 v21, v21, v29
    v_mul_f32 v22, v22, v30
    v_mul_f32 v23, v23, v31
    v_cvt_pk_bf16_f32 v24, v16, v17
    v_cvt_pk_bf16_f32 v25, v18, v19
    v_cvt_pk_bf16_f32 v26, v20, v21
    v_cvt_pk_bf16_f32 v27, v22, v23
    s_mov_b64 exec, s[54:55]
    ds_write_b128 v71, v[24:27]
    s_mov_b64 exec, -1
    s_waitcnt lgkmcnt(0)
    s_barrier
c0_mf:
    s_setprio 1
    ds_read_b128 v[32:35], v2 offset:0
    ds_read_b128 v[36:39], v2 offset:272
    ds_read_b128 v[40:43], v2 offset:544
    ds_read_b128 v[44:47], v2 offset:5120
    ds_read_b128 v[48:51], v2 offset:5392
    ds_read_b128 v[52:55], v2 offset:5664
    ds_read_b128 v[56:59], v2 offset:10240
    s_waitcnt vmcnt(17) lgkmcnt(6)
    v_mfma_f32_32x32x16_bf16 v[80:95], v[112:115], v[32:35], 0
    ds_read_b128 v[60:63], v2 offset:10512
    s_waitcnt vmcnt(16) lgkmcnt(6)
    v_mfma_f32_32x32x16_bf16 v[80:95], v[116:119], v[36:39], v[80:95]
    ds_read_b128 v[32:35], v2 offset:10240
    s_waitcnt vmcnt(15) lgkmcnt(6)
    v_mfma_f32_32x32x16_bf16 v[80:95], v[120:123], v[40:43], v[80:95]
    ds_read_b128 v[36:39], v2 offset:10784
    s_waitcnt vmcnt(14) lgkmcnt(6)
    v_mfma_f32_32x32x16_bf16 v[80:95], v[124:127], v[44:47], v[80:95]
    ds_read_b128 v[40:43], v2 offset:10512
    s_waitcnt vmcnt(13) lgkmcnt(6)
    v_mfma_f32_32x32x16_bf16 v[80:95], v[128:131], v[48:51], v[80:95]
    ds_read_b128 v[44:47], v2 offset:32
    s_waitcnt vmcnt(12) lgkmcnt(6)
    v_mfma_f32_32x32x16_bf16 v[80:95], v[132:135], v[52:55], v[80:95]
    ds_read_b128 v[48:51], v2 offset:10784
    s_waitcnt vmcnt(11) lgkmcnt(6)
    v_mfma_f32_32x32x16_bf16 v[80:95], v[136:139], v[56:59], v[80:95]
    ds_read_b128 v[52:55], v2 offset:304
    s_waitcnt vmcnt(10) lgkmcnt(6)
    v_mfma_f32_32x32x16_bf16 v[80:95], v[140:143], v[60:63], v[80:95]
    ds_read_b128 v[56:59], v2 offset:15360
    s_waitcnt lgkmcnt(6)
    v_mfma_f32_32x32x16_bf16 v[96:111], v[112:115], v[32:35], 0
    ds_read_b128 v[60:63], v2 offset:576
    s_waitcnt vmcnt(9) lgkmcnt(6)
    v_mfma_f32_32x32x16_bf16 v[80:95], v[144:147], v[36:39], v[80:95]
    ds_read_b128 v[32:35], v2 offset:15632
    s_waitcnt lgkmcnt(6)
    v_mfma_f32_32x32x16_bf16 v[96:111], v[116:119], v[40:43], v[96:111]
    ds_read_b128 v[36:39], v2 offset:5152
    s_waitcnt vmcnt(8) lgkmcnt(6)
    v_mfma_f32_32x32x16_bf16 v[80:95], v[148:151], v[44:47], v[80:95]
    ds_read_b128 v[40:43], v2 offset:15904
    s_waitcnt lgkmcnt(6)
    v_mfma_f32_32x32x16_bf16 v[96:111], v[120:123], v[48:51], v[96:111]
    ds_read_b128 v[44:47], v2 offset:5424
    s_waitcnt vmcnt(7) lgkmcnt(6)
    v_mfma_f32_32x32x16_bf16 v[80:95], v[152:155], v[52:55], v[80:95]
    ds_read_b128 v[48:51], v2 offset:20480
    s_waitcnt lgkmcnt(6)
    v_mfma_f32_32x32x16_bf16 v[96:111], v[124:127], v[56:59], v[96:111]
    ds_read_b128 v[52:55], v2 offset:5696
    s_waitcnt vmcnt(6) lgkmcnt(6)
    v_mfma_f32_32x32x16_bf16 v[80:95], v[156:159], v[60:63], v[80:95]
    ds_read_b128 v[56:59], v2 offset:20752
    s_waitcnt lgkmcnt(6)
    v_mfma_f32_32x32x16_bf16 v[96:111], v[128:131], v[32:35], v[96:111]
    ds_read_b128 v[60:63], v2 offset:10272
    s_waitcnt vmcnt(5) lgkmcnt(6)
    v_mfma_f32_32x32x16_bf16 v[80:95], v[160:163], v[36:39], v[80:95]
    ds_read_b128 v[32:35], v2 offset:21024
    s_waitcnt lgkmcnt(6)
    v_mfma_f32_32x32x16_bf16 v[96:111], v[132:135], v[40:43], v[96:111]
    ds_read_b128 v[36:39], v2 offset:10544
    s_waitcnt vmcnt(4) lgkmcnt(6)
    v_mfma_f32_32x32x16_bf16 v[80:95], v[164:167], v[44:47], v[80:95]
    ds_read_b128 v[40:43], v2 offset:10272
    s_waitcnt lgkmcnt(6)
    v_mfma_f32_32x32x16_bf16 v[96:111], v[136:139], v[48:51], v[96:111]
    ds_read_b128 v[44:47], v2 offset:10816
    s_waitcnt vmcnt(3) lgkmcnt(6)
    v_mfma_f32_32x32x16_bf16 v[80:95], v[168:171], v[52:55], v[80:95]
    ds_read_b128 v[48:51], v2 offset:10544
    s_waitcnt lgkmcnt(6)
    v_mfma_f32_32x32x16_bf16 v[96:111], v[140:143], v[56:59], v[96:111]
    ds_read_b128 v[52:55], v2 offset:10816
    s_waitcnt vmcnt(2) lgkmcnt(6)
    v_mfma_f32_32x32x16_bf16 v[80:95], v[172:175], v[60:63], v[80:95]
    ds_read_b128 v[56:59], v2 offset:15392
    s_waitcnt lgkmcnt(6)
    v_mfma_f32_32x32x16_bf16 v[96:111], v[144:147], v[32:35], v[96:111]
    ds_read_b128 v[60:63], v2 offset:15664
    s_waitcnt vmcnt(1) lgkmcnt(6)
    v_mfma_f32_32x32x16_bf16 v[80:95], v[176:179], v[36:39], v[80:95]
    ds_read_b128 v[32:35], v2 offset:15936
    s_waitcnt lgkmcnt(6)
    v_mfma_f32_32x32x16_bf16 v[96:111], v[148:151], v[40:43], v[96:111]
    ds_read_b128 v[36:39], v2 offset:20512
    s_waitcnt vmcnt(0) lgkmcnt(6)
    v_mfma_f32_32x32x16_bf16 v[80:95], v[180:183], v[44:47], v[80:95]
    ds_read_b128 v[40:43], v2 offset:20784
    s_waitcnt lgkmcnt(6)
    v_mfma_f32_32x32x16_bf16 v[96:111], v[152:155], v[48:51], v[96:111]
    ds_read_b128 v[44:47], v2 offset:21056
    s_waitcnt lgkmcnt(6)
    v_mfma_f32_32x32x16_bf16 v[96:111], v[156:159], v[52:55], v[96:111]
    ds_write_b128 v3, v[80:83] offset:0
    s_waitcnt lgkmcnt(6)
    v_mfma_f32_32x32x16_bf16 v[96:111], v[160:163], v[56:59], v[96:111]
    ds_write_b128 v3, v[84:87] offset:32
    s_waitcnt lgkmcnt(6)
    v_mfma_f32_32x32x16_bf16 v[96:111], v[164:167], v[60:63], v[96:111]
    ds_write_b128 v3, v[88:91] offset:64
    s_waitcnt lgkmcnt(6)
    v_mfma_f32_32x32x16_bf16 v[96:111], v[168:171], v[32:35], v[96:111]
    ds_write_b128 v3, v[92:95] offset:96
    s_waitcnt lgkmcnt(6)
    v_mfma_f32_32x32x16_bf16 v[96:111], v[172:175], v[36:39], v[96:111]
    s_waitcnt lgkmcnt(5)
    v_mfma_f32_32x32x16_bf16 v[96:111], v[176:179], v[40:43], v[96:111]
    s_waitcnt lgkmcnt(4)
    v_mfma_f32_32x32x16_bf16 v[96:111], v[180:183], v[44:47], v[96:111]
    s_setprio 0
    s_cmp_lt_u32 s33, 4
    s_cbranch_scc0 c0_hb
    s_cmp_eq_u32 s33, 3
    s_cbranch_scc0 c0_ne3
    v_add_f32 v216, v216, v217
    v_add_f32 v218, v218, v219
    v_add_f32 v220, v220, v221
    v_add_f32 v222, v222, v223
    v_add_f32 v216, v216, v218
    v_add_f32 v220, v220, v222
    v_add_f32 v216, v216, v220
    v_lshlrev_b32 v16, 2, v1
    v_add_u32 v16, 102656, v16
    ds_write_b32 v16, v216
c0_ne3:
    s_barrier
c0_hb:
    s_nop 7
    s_nop 3
    ds_write_b128 v3, v[96:99] offset:8704
    ds_write_b128 v3, v[100:103] offset:8736
    ds_write_b128 v3, v[104:107] offset:8768
    ds_write_b128 v3, v[108:111] offset:8800
    s_cmp_lt_u32 s33, 4
    s_cbranch_scc0 c0_hw
    global_load_dwordx4 v[184:187], v65, s[100:101] offset:0 sc1
    global_load_dwordx4 v[188:191], v65, s[100:101] offset:1024 sc1
    global_load_dwordx4 v[192:195], v65, s[100:101] offset:2048 sc1
    global_load_dwordx4 v[196:199], v65, s[100:101] offset:3072 sc1
    v_add_u32 v65, 4096, v65
    global_load_dwordx4 v[200:203], v65, s[100:101] offset:0 sc1
    global_load_dwordx4 v[204:207], v65, s[100:101] offset:1024 sc1
    global_load_dwordx4 v[208:211], v65, s[100:101] offset:2048 sc1
    global_load_dwordx4 v[212:215], v65, s[100:101] offset:3072 sc1
    v_add_u32 v65, 4096, v65
    global_load_dwordx4 v[216:219], v65, s[100:101] offset:0 sc1
    global_load_dwordx4 v[220:223], v65, s[100:101] offset:1024 sc1
    global_load_dwordx4 v[224:227], v65, s[100:101] offset:2048 sc1
    global_load_dwordx4 v[228:231], v65, s[100:101] offset:3072 sc1
    v_add_u32 v65, 4096, v65
    global_load_dwordx4 v[232:235], v65, s[100:101] offset:0 sc1
    global_load_dwordx4 v[236:239], v65, s[100:101] offset:1024 sc1
    global_load_dwordx4 v[240:243], v65, s[100:101] offset:2048 sc1
    global_load_dwordx4 v[244:247], v65, s[100:101] offset:3072 sc1
    v_add_u32 v65, 4096, v65
    global_load_dwordx4 v[248:251], v65, s[100:101] offset:0 sc1
    global_load_dwordx4 v[252:255], v65, s[100:101] offset:1024 sc1
c0_hw:
    s_waitcnt lgkmcnt(0)
    s_barrier
    v_lshrrev_b32 v2, 3, v0
    v_mul_u32_u24 v2, 272, v2
    v_and_b32 v3, 7, v0
    v_lshl_add_u32 v2, v3, 5, v2
    v_add_u32 v2, 30720, v2
    ds_read_b128 v[32:35], v2 offset:0
    ds_read_b128 v[36:39], v2 offset:16
    ds_read_b128 v[40:43], v2 offset:17408
    ds_read_b128 v[44:47], v2 offset:17424
    ds_read_b128 v[48:51], v2 offset:34816
    ds_read_b128 v[52:55], v2 offset:34832
    ds_read_b128 v[56:59], v2 offset:52224
    ds_read_b128 v[60:63], v2 offset:52240
    v_and_b32 v3, 7, v0
    v_lshlrev_b32 v3, 5, v3
    v_add_u32 v3, 102656, v3
    ds_read_b128 v[24:27], v3
    ds_read_b128 v[28:31], v3 offset:16
    v_lshrrev_b32 v20, 3, v0
    v_lshrrev_b32 v21, 4, v20
    v_and_b32 v20, 15, v20
    v_lshl_add_u32 v20, v21, 6, v20
    v_lshlrev_b32 v20, 8, v20
    v_and_b32 v21, 7, v0
    v_lshl_add_u32 v20, v21, 4, v20
    s_lshl_b32 s38, s31, 16
    s_lshl_b32 s39, s32, 12
    s_add_u32 s38, s38, s39
    s_lshl_b32 s39, s30, 7
    s_add_u32 s38, s38, s39
    v_add_u32 v20, s38, v20
    s_waitcnt lgkmcnt(6)
    v_pk_add_f32 v[32:33], v[32:33], v[40:41]
    v_pk_add_f32 v[34:35], v[34:35], v[42:43]
    v_pk_add_f32 v[36:37], v[36:37], v[44:45]
    v_pk_add_f32 v[38:39], v[38:39], v[46:47]
    s_waitcnt lgkmcnt(2)
    v_pk_add_f32 v[48:49], v[48:49], v[56:57]
    v_pk_add_f32 v[50:51], v[50:51], v[58:59]
    v_pk_add_f32 v[52:53], v[52:53], v[60:61]
    v_pk_add_f32 v[54:55], v[54:55], v[62:63]
    s_waitcnt lgkmcnt(0)
    v_pk_add_f32 v[32:33], v[32:33], v[24:25]
    v_pk_add_f32 v[34:35], v[34:35], v[26:27]
    v_pk_add_f32 v[36:37], v[36:37], v[28:29]
    v_pk_add_f32 v[38:39], v[38:39], v[30:31]
    v_pk_add_f32 v[32:33], v[32:33], v[48:49]
    v_pk_add_f32 v[34:35], v[34:35], v[50:51]
    v_pk_add_f32 v[36:37], v[36:37], v[52:53]
    v_pk_add_f32 v[38:39], v[38:39], v[54:55]
    v_cvt_pk_bf16_f32 v16, v32, v33
    v_cvt_pk_bf16_f32 v17, v34, v35
    v_cvt_pk_bf16_f32 v18, v36, v37
    v_cvt_pk_bf16_f32 v19, v38, v39
    global_store_dwordx4 v20, v[16:19], s[98:99] sc0 sc1
    v_mov_b32 v21, 0x3f803f80
    v_mov_b32 v4, 0
    v_mov_b32 v5, 0
    v_dot2_f32_bf16 v4, v16, v21, v4
    v_dot2_f32_bf16 v5, v16, v16, v5
    v_dot2_f32_bf16 v4, v17, v21, v4
    v_dot2_f32_bf16 v5, v17, v17, v5
    v_dot2_f32_bf16 v4, v18, v21, v4
    v_dot2_f32_bf16 v5, v18, v18, v5
    v_dot2_f32_bf16 v4, v19, v21, v4
    v_dot2_f32_bf16 v5, v19, v19, v5
    s_nop 3
    v_add_f32_dpp v4, v4, v4 quad_perm:[1,0,3,2] row_mask:0xf bank_mask:0xf
    v_add_f32_dpp v5, v5, v5 quad_perm:[1,0,3,2] row_mask:0xf bank_mask:0xf
    s_nop 0
    v_add_f32_dpp v4, v4, v4 quad_perm:[2,3,0,1] row_mask:0xf bank_mask:0xf
    v_add_f32_dpp v5, v5, v5 quad_perm:[2,3,0,1] row_mask:0xf bank_mask:0xf
    s_nop 0
    v_add_f32_dpp v4, v4, v4 row_ror:8 row_mask:0xf bank_mask:0xf
    v_add_f32_dpp v5, v5, v5 row_ror:8 row_mask:0xf bank_mask:0xf
    s_nop 0
    v_mov_b32 v22, v4
    v_mov_b32 v23, v5
    s_nop 1
    v_permlane16_swap_b32 v4, v22
    v_permlane16_swap_b32 v5, v23
    s_nop 1
    v_add_f32 v4, v4, v22
    v_add_f32 v5, v5, v23
    s_nop 1
    v_mov_b32 v22, v4
    v_mov_b32 v23, v5
    s_nop 1
    v_permlane32_swap_b32 v4, v22
    v_permlane32_swap_b32 v5, v23
    s_nop 1
    v_add_f32 v4, v4, v22
    v_add_f32 v5, v5, v23
    s_nop 1
    v_bfe_u32 v22, v1, 2, 1
    s_lshl_b32 s38, s33, 1
    v_add_u32 v22, s38, v22
    v_lshlrev_b32 v22, 3, v22
    v_add_u32 v22, 100416, v22
    s_mov_b64 exec, 0x11
    ds_write_b64 v22, v[4:5]
    s_mov_b64 exec, -1
    s_waitcnt lgkmcnt(0)
    s_barrier
    s_cmp_eq_u32 s33, 0
    s_cbranch_scc0 e1_nw0
    v_and_b32 v16, 15, v1
    v_lshlrev_b32 v16, 3, v16
    v_add_u32 v16, 100416, v16
    ds_read_b64 v[4:5], v16
    s_waitcnt lgkmcnt(0)
    v_add_f32_dpp v4, v4, v4 quad_perm:[2,3,0,1] row_mask:0xf bank_mask:0xf
    v_add_f32_dpp v5, v5, v5 quad_perm:[2,3,0,1] row_mask:0xf bank_mask:0xf
    s_nop 0
    v_add_f32_dpp v4, v4, v4 row_ror:4 row_mask:0xf bank_mask:0xf
    v_add_f32_dpp v5, v5, v5 row_ror:4 row_mask:0xf bank_mask:0xf
    s_nop 0
    v_add_f32_dpp v4, v4, v4 row_ror:8 row_mask:0xf bank_mask:0xf
    v_add_f32_dpp v5, v5, v5 row_ror:8 row_mask:0xf bank_mask:0xf
    s_nop 0
e1_nw0:
    s_waitcnt vmcnt(0)
    s_barrier
    s_cmp_eq_u32 s33, 0
    s_cbranch_scc0 p2_pub
    s_mov_b64 exec, 3
    v_mov_b32 v20, v4
    v_mov_b32 v21, v5
    v_mov_b32 v22, s34
    v_mov_b32 v23, 0
    v_lshlrev_b32 v16, 4, v1
    global_store_dwordx4 v16, v[20:23], s[96:97] sc0 sc1
    s_nop 1
    s_mov_b64 exec, -1
p2_pub:
    global_load_dwordx4 v[96:99], v6, s[16:17]
    global_load_dwordx4 v[100:103], v6, s[18:19]
    global_load_dwordx4 v[104:107], v6, s[16:17] offset:128
    global_load_dwordx4 v[108:111], v6, s[18:19] offset:128
    s_cmp_eq_u32 s33, 0
    s_cbranch_scc0 p2_skip
    v_lshlrev_b32 v16, 4, v1
    s_mov_b32 s40, 0x20000
    global_load_dwordx4 v[144:147], v16, s[92:93] offset:0 sc1
    global_load_dwordx4 v[148:151], v16, s[92:93] offset:1024 sc1
    global_load_dwordx4 v[152:155], v16, s[92:93] offset:2048 sc1
    global_load_dwordx4 v[156:159], v16, s[92:93] offset:3072 sc1
p2_loop:
    s_waitcnt vmcnt(0)
    v_cmp_eq_u32 vcc, s34, v146
    v_cmp_eq_u32 s[42:43], s34, v150
    v_cmp_eq_u32 s[52:53], s34, v154
    v_cmp_eq_u32 s[54:55], s34, v158
    s_nop 1
    s_and_b64 vcc, vcc, s[42:43]
    s_and_b64 s[52:53], s[52:53], s[54:55]
    s_and_b64 vcc, vcc, s[52:53]
    s_cmp_eq_u64 vcc, -1
    s_cbranch_scc1 p2_x0
    global_load_dwordx4 v[144:147], v16, s[92:93] offset:0 sc1
    global_load_dwordx4 v[148:151], v16, s[92:93] offset:1024 sc1
    global_load_dwordx4 v[152:155], v16, s[92:93] offset:2048 sc1
    global_load_dwordx4 v[156:159], v16, s[92:93] offset:3072 sc1
    s_sub_u32 s40, s40, 1
    s_cmp_lg_u32 s40, 0
    s_cbranch_scc1 p2_loop
    s_waitcnt vmcnt(0)
p2_x0:
    v_add_f32 v32, v144, v148
    v_add_f32 v33, v145, v149
    v_add_f32 v40, v152, v156
    v_add_f32 v41, v153, v157
p2_done:
    s_branch p2_go
p2_skip:
    s_waitcnt vmcnt(0)
p2_go:
    s_barrier
    global_load_dwordx4 v[48:51], v8, s[98:99] sc1
    global_load_dwordx4 v[52:55], v9, s[98:99] sc1
    s_cmp_lt_u32 s33, 4
    s_cbranch_scc1 tl1_l
    global_load_dwordx4 v[80:83], v10, s[98:99] sc1
    global_load_dwordx4 v[84:87], v11, s[98:99] sc1
    global_load_dwordx4 v[88:91], v68, s[98:99] sc1
    global_load_dwordx4 v[92:95], v69, s[98:99] sc1
    s_branch tl1_e
tl1_l:
tl1_e:
    s_cmp_eq_u32 s33, 0
    s_cbranch_scc0 s2_nw0
    v_add_f32 v32, v32, v40
    v_add_f32 v33, v33, v41
    s_nop 1
    v_add_f32_dpp v32, v32, v32 row_ror:8 row_mask:0xf bank_mask:0xf
    v_add_f32_dpp v33, v33, v33 row_ror:8 row_mask:0xf bank_mask:0xf
    s_nop 0
    v_add_f32_dpp v32, v32, v32 row_ror:4 row_mask:0xf bank_mask:0xf
    v_add_f32_dpp v33, v33, v33 row_ror:4 row_mask:0xf bank_mask:0xf
    s_nop 0
    v_mov_b32 v34, v32
    v_mov_b32 v35, v33
    s_nop 1
    v_permlane16_swap_b32 v32, v34
    v_permlane16_swap_b32 v33, v35
    s_nop 1
    v_add_f32 v32, v32, v34
    v_add_f32 v33, v33, v35
    s_nop 1
    v_mov_b32 v34, v32
    v_mov_b32 v35, v33
    s_nop 1
    v_permlane32_swap_b32 v32, v34
    v_permlane32_swap_b32 v33, v35
    s_nop 1
    v_add_f32 v32, v32, v34
    v_add_f32 v33, v33, v35
    s_nop 1
    v_mul_f32 v32, 0x37000000, v32
    v_mul_f32 v33, 0x37000000, v33
    v_fma_f32 v33, -v32, v32, v33
    v_max_f32 v33, 0, v33
    v_add_f32 v33, 0x3727c5ac, v33
    v_rsq_f32 v33, v33
    v_lshlrev_b32 v34, 3, v1
    v_add_u32 v34, 100352, v34
    s_mov_b64 exec, 15
    ds_write_b64 v34, v[32:33]
    s_mov_b64 exec, -1
s2_nw0:
    s_waitcnt lgkmcnt(0)
    s_barrier
    v_bfe_u32 v16, v0, 2, 1
    v_lshlrev_b32 v16, 3, v16
    v_add_u32 v16, 100352, v16
    ds_read_b64 v[16:17], v16
    v_lshlrev_b32 v32, 16, v96
    v_and_b32 v33, 0xffff0000, v96
    v_lshlrev_b32 v40, 16, v100
    v_and_b32 v41, 0xffff0000, v100
    v_lshlrev_b32 v34, 16, v97
    v_and_b32 v35, 0xffff0000, v97
    v_lshlrev_b32 v42, 16, v101
    v_and_b32 v43, 0xffff0000, v101
    v_lshlrev_b32 v36, 16, v98
    v_and_b32 v37, 0xffff0000, v98
    v_lshlrev_b32 v44, 16, v102
    v_and_b32 v45, 0xffff0000, v102
    v_lshlrev_b32 v38, 16, v99
    v_and_b32 v39, 0xffff0000, v99
    v_lshlrev_b32 v46, 16, v103
    v_and_b32 v47, 0xffff0000, v103
    v_pk_mul_f32 v[40:41], v[40:41], s[56:57]
    v_pk_mul_f32 v[42:43], v[42:43], s[56:57]
    v_pk_mul_f32 v[44:45], v[44:45], s[56:57]
    v_pk_mul_f32 v[46:47], v[46:47], s[56:57]
    s_waitcnt lgkmcnt(0)
    v_mul_f32 v17, s56, v17
    s_nop 0
    v_pk_mul_f32 v[32:33], v[32:33], v[16:17] op_sel:[0,1] op_sel_hi:[1,1]
    v_pk_mul_f32 v[34:35], v[34:35], v[16:17] op_sel:[0,1] op_sel_hi:[1,1]
    v_pk_mul_f32 v[36:37], v[36:37], v[16:17] op_sel:[0,1] op_sel_hi:[1,1]
    v_pk_mul_f32 v[38:39], v[38:39], v[16:17] op_sel:[0,1] op_sel_hi:[1,1]
    v_pk_fma_f32 v[40:41], v[32:33], v[16:17], v[40:41] op_sel:[0,0,0] op_sel_hi:[1,0,1] neg_lo:[1,0,0] neg_hi:[1,0,0]
    v_pk_fma_f32 v[42:43], v[34:35], v[16:17], v[42:43] op_sel:[0,0,0] op_sel_hi:[1,0,1] neg_lo:[1,0,0] neg_hi:[1,0,0]
    v_pk_fma_f32 v[44:45], v[36:37], v[16:17], v[44:45] op_sel:[0,0,0] op_sel_hi:[1,0,1] neg_lo:[1,0,0] neg_hi:[1,0,0]
    v_pk_fma_f32 v[46:47], v[38:39], v[16:17], v[46:47] op_sel:[0,0,0] op_sel_hi:[1,0,1] neg_lo:[1,0,0] neg_hi:[1,0,0]
    s_cmp_lt_u32 s33, 4
    s_cbranch_scc1 c1_wl
    v_bfe_u32 v16, v0, 2, 1
    v_lshlrev_b32 v16, 3, v16
    v_add_u32 v16, 100368, v16
    ds_read_b64 v[16:17], v16
    v_lshlrev_b32 v128, 16, v104
    v_and_b32 v129, 0xffff0000, v104
    v_lshlrev_b32 v136, 16, v108
    v_and_b32 v137, 0xffff0000, v108
    v_lshlrev_b32 v130, 16, v105
    v_and_b32 v131, 0xffff0000, v105
    v_lshlrev_b32 v138, 16, v109
    v_and_b32 v139, 0xffff0000, v109
    v_lshlrev_b32 v132, 16, v106
    v_and_b32 v133, 0xffff0000, v106
    v_lshlrev_b32 v140, 16, v110
    v_and_b32 v141, 0xffff0000, v110
    v_lshlrev_b32 v134, 16, v107
    v_and_b32 v135, 0xffff0000, v107
    v_lshlrev_b32 v142, 16, v111
    v_and_b32 v143, 0xffff0000, v111
    v_pk_mul_f32 v[136:137], v[136:137], s[56:57]
    v_pk_mul_f32 v[138:139], v[138:139], s[56:57]
    v_pk_mul_f32 v[140:141], v[140:141], s[56:57]
    v_pk_mul_f32 v[142:143], v[142:143], s[56:57]
    s_waitcnt lgkmcnt(0)
    v_mul_f32 v17, s56, v17
    s_nop 0
    v_pk_mul_f32 v[128:129], v[128:129], v[16:17] op_sel:[0,1] op_sel_hi:[1,1]
    v_pk_mul_f32 v[130:131], v[130:131], v[16:17] op_sel:[0,1] op_sel_hi:[1,1]
    v_pk_mul_f32 v[132:133], v[132:133], v[16:17] op_sel:[0,1] op_sel_hi:[1,1]
    v_pk_mul_f32 v[134:135], v[134:135], v[16:17] op_sel:[0,1] op_sel_hi:[1,1]
    v_pk_fma_f32 v[136:137], v[128:129], v[16:17], v[136:137] op_sel:[0,0,0] op_sel_hi:[1,0,1] neg_lo:[1,0,0] neg_hi:[1,0,0]
    v_pk_fma_f32 v[138:139], v[130:131], v[16:17], v[138:139] op_sel:[0,0,0] op_sel_hi:[1,0,1] neg_lo:[1,0,0] neg_hi:[1,0,0]
    v_pk_fma_f32 v[140:141], v[132:133], v[16:17], v[140:141] op_sel:[0,0,0] op_sel_hi:[1,0,1] neg_lo:[1,0,0] neg_hi:[1,0,0]
    v_pk_fma_f32 v[142:143], v[134:135], v[16:17], v[142:143] op_sel:[0,0,0] op_sel_hi:[1,0,1] neg_lo:[1,0,0] neg_hi:[1,0,0]
    s_waitcnt vmcnt(4)
    v_lshlrev_b32 v16, 16, v48
    v_and_b32 v17, 0xffff0000, v48
    v_lshlrev_b32 v18, 16, v49
    v_and_b32 v19, 0xffff0000, v49
    v_lshlrev_b32 v20, 16, v50
    v_and_b32 v21, 0xffff0000, v50
    v_lshlrev_b32 v22, 16, v51
    v_and_b32 v23, 0xffff0000, v51
    v_pk_fma_f32 v[16:17], v[16:17], v[32:33], v[40:41]
    v_pk_fma_f32 v[18:19], v[18:19], v[34:35], v[42:43]
    v_pk_fma_f32 v[20:21], v[20:21], v[36:37], v[44:45]
    v_pk_fma_f32 v[22:23], v[22:23], v[38:39], v[46:47]
    v_exp_f32 v24, v16
    v_exp_f32 v25, v17
    v_exp_f32 v26, v18
    v_exp_f32 v27, v19
    v_exp_f32 v28, v20
    v_exp_f32 v29, v21
    v_exp_f32 v30, v22
    v_exp_f32 v31, v23
    v_pk_fma_f32 v[24:25], v[24:25], s[56:57], s[56:57]
    v_pk_fma_f32 v[26:27], v[26:27], s[56:57], s[56:57]
    v_pk_fma_f32 v[28:29], v[28:29], s[56:57], s[56:57]
    v_pk_fma_f32 v[30:31], v[30:31], s[56:57], s[56:57]
    v_rcp_f32 v24, v24
    v_lshlrev_b32 v112, 16, v52
    v_rcp_f32 v25, v25
    v_and_b32 v113, 0xffff0000, v52
    v_lshlrev_b32 v114, 16, v53
    v_rcp_f32 v26, v26
    v_and_b32 v115, 0xffff0000, v53
    v_rcp_f32 v27, v27
    v_lshlrev_b32 v116, 16, v54
    v_and_b32 v117, 0xffff0000, v54
    v_rcp_f32 v28, v28
    v_lshlrev_b32 v118, 16, v55
    v_rcp_f32 v29, v29
    v_and_b32 v119, 0xffff0000, v55
    v_pk_fma_f32 v[112:113], v[112:113], v[32:33], v[40:41]
    v_rcp_f32 v30, v30
    v_pk_fma_f32 v[114:115], v[114:115], v[34:35], v[42:43]
    v_rcp_f32 v31, v31
    v_pk_fma_f32 v[116:117], v[116:117], v[36:37], v[44:45]
    v_pk_fma_f32 v[118:119], v[118:119], v[38:39], v[46:47]
    v_exp_f32 v120, v112
    v_pk_mul_f32 v[16:17], v[16:17], v[24:25]
    v_exp_f32 v121, v113
    v_pk_mul_f32 v[18:19], v[18:19], v[26:27]
    v_exp_f32 v122, v114
    v_pk_mul_f32 v[20:21], v[20:21], v[28:29]
    v_exp_f32 v123, v115
    v_pk_mul_f32 v[22:23], v[22:23], v[30:31]
    v_exp_f32 v124, v116
    v_cvt_pk_bf16_f32 v24, v16, v17
    v_exp_f32 v125, v117
    v_cvt_pk_bf16_f32 v25, v18, v19
    v_exp_f32 v126, v118
    v_cvt_pk_bf16_f32 v26, v20, v21
    v_exp_f32 v127, v119
    v_cvt_pk_bf16_f32 v27, v22, v23
    s_mov_b64 exec, s[44:45]
    ds_write_b128 v12, v[24:27]
    s_mov_b64 exec, -1
    v_pk_fma_f32 v[120:121], v[120:121], s[56:57], s[56:57]
    v_pk_fma_f32 v[122:123], v[122:123], s[56:57], s[56:57]
    v_pk_fma_f32 v[124:125], v[124:125], s[56:57], s[56:57]
    v_pk_fma_f32 v[126:127], v[126:127], s[56:57], s[56:57]
    v_rcp_f32 v120, v120
    v_rcp_f32 v121, v121
    v_rcp_f32 v122, v122
    v_rcp_f32 v123, v123
    v_rcp_f32 v124, v124
    v_rcp_f32 v125, v125
    v_rcp_f32 v126, v126
    v_rcp_f32 v127, v127
    s_nop 0
    v_pk_mul_f32 v[112:113], v[112:113], v[120:121]
    v_pk_mul_f32 v[114:115], v[114:115], v[122:123]
    v_pk_mul_f32 v[116:117], v[116:117], v[124:125]
    v_pk_mul_f32 v[118:119], v[118:119], v[126:127]
    v_cvt_pk_bf16_f32 v120, v112, v113
    v_cvt_pk_bf16_f32 v121, v114, v115
    v_cvt_pk_bf16_f32 v122, v116, v117
    v_cvt_pk_bf16_f32 v123, v118, v119
    s_mov_b64 exec, s[46:47]
    ds_write_b128 v13, v[120:123]
    s_mov_b64 exec, -1
    s_waitcnt vmcnt(3)
    v_lshlrev_b32 v16, 16, v80
    v_and_b32 v17, 0xffff0000, v80
    v_lshlrev_b32 v18, 16, v81
    v_and_b32 v19, 0xffff0000, v81
    v_lshlrev_b32 v20, 16, v82
    v_and_b32 v21, 0xffff0000, v82
    v_lshlrev_b32 v22, 16, v83
    v_and_b32 v23, 0xffff0000, v83
    v_pk_fma_f32 v[16:17], v[16:17], v[128:129], v[136:137]
    v_pk_fma_f32 v[18:19], v[18:19], v[130:131], v[138:139]
    v_pk_fma_f32 v[20:21], v[20:21], v[132:133], v[140:141]
    v_pk_fma_f32 v[22:23], v[22:23], v[134:135], v[142:143]
    v_exp_f32 v24, v16
    v_exp_f32 v25, v17
    v_exp_f32 v26, v18
    v_exp_f32 v27, v19
    v_exp_f32 v28, v20
    v_exp_f32 v29, v21
    v_exp_f32 v30, v22
    v_exp_f32 v31, v23
    v_pk_fma_f32 v[24:25], v[24:25], s[56:57], s[56:57]
    v_pk_fma_f32 v[26:27], v[26:27], s[56:57], s[56:57]
    v_pk_fma_f32 v[28:29], v[28:29], s[56:57], s[56:57]
    v_pk_fma_f32 v[30:31], v[30:31], s[56:57], s[56:57]
    v_rcp_f32 v24, v24
    v_rcp_f32 v25, v25
    v_rcp_f32 v26, v26
    v_rcp_f32 v27, v27
    v_rcp_f32 v28, v28
    v_rcp_f32 v29, v29
    v_rcp_f32 v30, v30
    v_rcp_f32 v31, v31
    s_nop 0
    v_pk_mul_f32 v[16:17], v[16:17], v[24:25]
    v_pk_mul_f32 v[18:19], v[18:19], v[26:27]
    v_pk_mul_f32 v[20:21], v[20:21], v[28:29]
    v_pk_mul_f32 v[22:23], v[22:23], v[30:31]
    v_cvt_pk_bf16_f32 v24, v16, v17
    v_cvt_pk_bf16_f32 v25, v18, v19
    v_cvt_pk_bf16_f32 v26, v20, v21
    v_cvt_pk_bf16_f32 v27, v22, v23
    s_mov_b64 exec, s[48:49]
    ds_write_b128 v14, v[24:27]
    s_mov_b64 exec, -1
    s_branch c1_w
c1_wl:
    s_waitcnt vmcnt(0)
    v_lshlrev_b32 v16, 16, v48
    v_and_b32 v17, 0xffff0000, v48
    v_lshlrev_b32 v18, 16, v49
    v_and_b32 v19, 0xffff0000, v49
    v_lshlrev_b32 v20, 16, v50
    v_and_b32 v21, 0xffff0000, v50
    v_lshlrev_b32 v22, 16, v51
    v_and_b32 v23, 0xffff0000, v51
    v_pk_fma_f32 v[16:17], v[16:17], v[32:33], v[40:41]
    v_pk_fma_f32 v[18:19], v[18:19], v[34:35], v[42:43]
    v_pk_fma_f32 v[20:21], v[20:21], v[36:37], v[44:45]
    v_pk_fma_f32 v[22:23], v[22:23], v[38:39], v[46:47]
    v_exp_f32 v24, v16
    v_exp_f32 v25, v17
    v_exp_f32 v26, v18
    v_exp_f32 v27, v19
    v_exp_f32 v28, v20
    v_exp_f32 v29, v21
    v_exp_f32 v30, v22
    v_exp_f32 v31, v23
    v_pk_fma_f32 v[24:25], v[24:25], s[56:57], s[56:57]
    v_pk_fma_f32 v[26:27], v[26:27], s[56:57], s[56:57]
    v_pk_fma_f32 v[28:29], v[28:29], s[56:57], s[56:57]
    v_pk_fma_f32 v[30:31], v[30:31], s[56:57], s[56:57]
    v_rcp_f32 v24, v24
    v_lshlrev_b32 v112, 16, v52
    v_rcp_f32 v25, v25
    v_and_b32 v113, 0xffff0000, v52
    v_lshlrev_b32 v114, 16, v53
    v_rcp_f32 v26, v26
    v_and_b32 v115, 0xffff0000, v53
    v_rcp_f32 v27, v27
    v_lshlrev_b32 v116, 16, v54
    v_and_b32 v117, 0xffff0000, v54
    v_rcp_f32 v28, v28
    v_lshlrev_b32 v118, 16, v55
    v_rcp_f32 v29, v29
    v_and_b32 v119, 0xffff0000, v55
    v_pk_fma_f32 v[112:113], v[112:113], v[32:33], v[40:41]
    v_rcp_f32 v30, v30
    v_pk_fma_f32 v[114:115], v[114:115], v[34:35], v[42:43]
    v_rcp_f32 v31, v31
    v_pk_fma_f32 v[116:117], v[116:117], v[36:37], v[44:45]
    v_pk_fma_f32 v[118:119], v[118:119], v[38:39], v[46:47]
    v_exp_f32 v120, v112
    v_pk_mul_f32 v[16:17], v[16:17], v[24:25]
    v_exp_f32 v121, v113
    v_pk_mul_f32 v[18:19], v[18:19], v[26:27]
    v_exp_f32 v122, v114
    v_pk_mul_f32 v[20:21], v[20:21], v[28:29]
    v_exp_f32 v123, v115
    v_pk_mul_f32 v[22:23], v[22:23], v[30:31]
    v_exp_f32 v124, v116
    v_cvt_pk_bf16_f32 v24, v16, v17
    v_exp_f32 v125, v117
    v_cvt_pk_bf16_f32 v25, v18, v19
    v_exp_f32 v126, v118
    v_cvt_pk_bf16_f32 v26, v20, v21
    v_exp_f32 v127, v119
    v_cvt_pk_bf16_f32 v27, v22, v23
    s_mov_b64 exec, s[44:45]
    ds_write_b128 v12, v[24:27]
    s_mov_b64 exec, -1
    v_pk_fma_f32 v[120:121], v[120:121], s[56:57], s[56:57]
    v_pk_fma_f32 v[122:123], v[122:123], s[56:57], s[56:57]
    v_pk_fma_f32 v[124:125], v[124:125], s[56:57], s[56:57]
    v_pk_fma_f32 v[126:127], v[126:127], s[56:57], s[56:57]
    v_rcp_f32 v120, v120
    v_rcp_f32 v121, v121
    v_rcp_f32 v122, v122
    v_rcp_f32 v123, v123
    v_rcp_f32 v124, v124
    v_rcp_f32 v125, v125
    v_rcp_f32 v126, v126
    v_rcp_f32 v127, v127
    s_nop 0
    v_pk_mul_f32 v[112:113], v[112:113], v[120:121]
    v_pk_mul_f32 v[114:115], v[114:115], v[122:123]
    v_pk_mul_f32 v[116:117], v[116:117], v[124:125]
    v_pk_mul_f32 v[118:119], v[118:119], v[126:127]
    v_cvt_pk_bf16_f32 v120, v112, v113
    v_cvt_pk_bf16_f32 v121, v114, v115
    v_cvt_pk_bf16_f32 v122, v116, v117
    v_cvt_pk_bf16_f32 v123, v118, v119
    s_mov_b64 exec, s[46:47]
    ds_write_b128 v13, v[120:123]
    s_mov_b64 exec, -1
c1_w:
    v_bfe_u32 v2, v1, 4, 1
    v_mul_u32_u24 v2, 5120, v2
    v_and_b32 v17, 15, v1
    v_mad_u32_u24 v2, v17, s60, v2
    v_lshrrev_b32 v17, 5, v1
    v_lshl_add_u32 v2, v17, 4, v2
    s_lshr_b32 s42, s33, 1
    s_lshl_b32 s42, s42, 6
    v_add_u32 v2, s42, v2
    v_and_b32 v18, 31, v1
    v_mul_u32_u24 v3, 272, v18
    v_lshl_add_u32 v3, v17, 4, v3
    s_lshr_b32 s42, s33, 1
    s_mul_i32 s42, s42, 17408
    s_and_b32 s43, s33, 1
    s_mul_i32 s43, s43, 8704
    s_add_u32 s42, s42, s43
    s_add_u32 s42, s42, 30720
    v_add_u32 v3, s42, v3
    s_waitcnt lgkmcnt(0)
    s_barrier
    s_cmp_lt_u32 s33, 4
    s_cbranch_scc1 c1_mf
    s_waitcnt vmcnt(0)
    global_load_dwordx4 v[184:187], v65, s[100:101] offset:0 sc1
    v_lshlrev_b32 v16, 16, v84
    v_and_b32 v17, 0xffff0000, v84
    v_lshlrev_b32 v18, 16, v85
    v_and_b32 v19, 0xffff0000, v85
    v_lshlrev_b32 v20, 16, v86
    v_and_b32 v21, 0xffff0000, v86
    v_lshlrev_b32 v22, 16, v87
    v_and_b32 v23, 0xffff0000, v87
    global_load_dwordx4 v[188:191], v65, s[100:101] offset:1024 sc1
    v_fma_f32 v16, v16, v128, v136
    v_fma_f32 v17, v17, v129, v137
    v_fma_f32 v18, v18, v130, v138
    v_fma_f32 v19, v19, v131, v139
    v_fma_f32 v20, v20, v132, v140
    v_fma_f32 v21, v21, v133, v141
    v_fma_f32 v22, v22, v134, v142
    v_fma_f32 v23, v23, v135, v143
    global_load_dwordx4 v[192:195], v65, s[100:101] offset:2048 sc1
    v_exp_f32 v24, v16
    v_exp_f32 v25, v17
    v_exp_f32 v26, v18
    v_exp_f32 v27, v19
    v_exp_f32 v28, v20
    v_exp_f32 v29, v21
    v_exp_f32 v30, v22
    v_exp_f32 v31, v23
    global_load_dwordx4 v[196:199], v65, s[100:101] offset:3072 sc1
    v_add_u32 v65, 4096, v65
    v_fma_f32 v24, v24, s56, s56
    v_fma_f32 v25, v25, s56, s56
    v_fma_f32 v26, v26, s56, s56
    v_fma_f32 v27, v27, s56, s56
    v_fma_f32 v28, v28, s56, s56
    v_fma_f32 v29, v29, s56, s56
    v_fma_f32 v30, v30, s56, s56
    v_fma_f32 v31, v31, s56, s56
    global_load_dwordx4 v[200:203], v65, s[100:101] offset:0 sc1
    v_rcp_f32 v24, v24
    v_lshlrev_b32 v48, 16, v88
    v_and_b32 v49, 0xffff0000, v88
    v_rcp_f32 v25, v25
    v_lshlrev_b32 v50, 16, v89
    v_and_b32 v51, 0xffff0000, v89
    v_rcp_f32 v26, v26
    v_lshlrev_b32 v52, 16, v90
    global_load_dwordx4 v[204:207], v65, s[100:101] offset:1024 sc1
    v_and_b32 v53, 0xffff0000, v90
    v_rcp_f32 v27, v27
    v_lshlrev_b32 v54, 16, v91
    v_and_b32 v55, 0xffff0000, v91
    v_rcp_f32 v28, v28
    v_fma_f32 v48, v48, v128, v136
    v_fma_f32 v49, v49, v129, v137
    v_rcp_f32 v29, v29
    global_load_dwordx4 v[208:211], v65, s[100:101] offset:2048 sc1
    v_fma_f32 v50, v50, v130, v138
    v_fma_f32 v51, v51, v131, v139
    v_rcp_f32 v30, v30
    v_fma_f32 v52, v52, v132, v140
    v_fma_f32 v53, v53, v133, v141
    v_rcp_f32 v31, v31
    v_fma_f32 v54, v54, v134, v142
    v_fma_f32 v55, v55, v135, v143
    global_load_dwordx4 v[212:215], v65, s[100:101] offset:3072 sc1
    v_add_u32 v65, 4096, v65
    v_exp_f32 v56, v48
    v_mul_f32 v16, v16, v24
    v_exp_f32 v57, v49
    v_mul_f32 v17, v17, v25
    v_mul_f32 v18, v18, v26
    v_exp_f32 v58, v50
    v_mul_f32 v19, v19, v27
    v_exp_f32 v59, v51
    global_load_dwordx4 v[216:219], v65, s[100:101] offset:0 sc1
    v_mul_f32 v20, v20, v28
    v_mul_f32 v21, v21, v29
    v_exp_f32 v60, v52
    v_mul_f32 v22, v22, v30
    v_exp_f32 v61, v53
    v_mul_f32 v23, v23, v31
    v_cvt_pk_bf16_f32 v24, v16, v17
    v_exp_f32 v62, v54
    global_load_dwordx4 v[220:223], v65, s[100:101] offset:1024 sc1
    v_cvt_pk_bf16_f32 v25, v18, v19
    v_exp_f32 v63, v55
    v_cvt_pk_bf16_f32 v26, v20, v21
    v_cvt_pk_bf16_f32 v27, v22, v23
    s_mov_b64 exec, s[50:51]
    ds_write_b128 v15, v[24:27]
    s_mov_b64 exec, -1
    v_fma_f32 v56, v56, s56, s56
    global_load_dwordx4 v[224:227], v65, s[100:101] offset:2048 sc1
    v_fma_f32 v57, v57, s56, s56
    v_fma_f32 v58, v58, s56, s56
    v_fma_f32 v59, v59, s56, s56
    v_fma_f32 v60, v60, s56, s56
    v_fma_f32 v61, v61, s56, s56
    v_fma_f32 v62, v62, s56, s56
    v_fma_f32 v63, v63, s56, s56
    v_rcp_f32 v56, v56
    global_load_dwordx4 v[228:231], v65, s[100:101] offset:3072 sc1
    v_add_u32 v65, 4096, v65
    v_lshlrev_b32 v16, 16, v92
    v_and_b32 v17, 0xffff0000, v92
    v_rcp_f32 v57, v57
    v_lshlrev_b32 v18, 16, v93
    v_and_b32 v19, 0xffff0000, v93
    v_rcp_f32 v58, v58
    v_lshlrev_b32 v20, 16, v94
    v_and_b32 v21, 0xffff0000, v94
    global_load_dwordx4 v[232:235], v65, s[100:101] offset:0 sc1
    v_rcp_f32 v59, v59
    v_lshlrev_b32 v22, 16, v95
    v_and_b32 v23, 0xffff0000, v95
    v_rcp_f32 v60, v60
    v_fma_f32 v16, v16, v128, v136
    v_fma_f32 v17, v17, v129, v137
    v_rcp_f32 v61, v61
    v_fma_f32 v18, v18, v130, v138
    global_load_dwordx4 v[236:239], v65, s[100:101] offset:1024 sc1
    v_fma_f32 v19, v19, v131, v139
    v_rcp_f32 v62, v62
    v_fma_f32 v20, v20, v132, v140
    v_fma_f32 v21, v21, v133, v141
    v_rcp_f32 v63, v63
    v_fma_f32 v22, v22, v134, v142
    v_fma_f32 v23, v23, v135, v143
    v_exp_f32 v24, v16
    global_load_dwordx4 v[240:243], v65, s[100:101] offset:2048 sc1
    v_mul_f32 v48, v48, v56
    v_exp_f32 v25, v17
    v_mul_f32 v49, v49, v57
    v_mul_f32 v50, v50, v58
    v_exp_f32 v26, v18
    v_mul_f32 v51, v51, v59
    v_exp_f32 v27, v19
    v_mul_f32 v52, v52, v60
    global_load_dwordx4 v[244:247], v65, s[100:101] offset:3072 sc1
    v_add_u32 v65, 4096, v65
    v_mul_f32 v53, v53, v61
    v_exp_f32 v28, v20
    v_mul_f32 v54, v54, v62
    v_exp_f32 v29, v21
    v_mul_f32 v55, v55, v63
    v_cvt_pk_bf16_f32 v56, v48, v49
    v_exp_f32 v30, v22
    v_cvt_pk_bf16_f32 v57, v50, v51
    global_load_dwordx4 v[248:251], v65, s[100:101] offset:0 sc1
    v_exp_f32 v31, v23
    v_cvt_pk_bf16_f32 v58, v52, v53
    v_cvt_pk_bf16_f32 v59, v54, v55
    s_mov_b64 exec, s[52:53]
    ds_write_b128 v70, v[56:59]
    s_mov_b64 exec, -1
    v_fma_f32 v24, v24, s56, s56
    v_fma_f32 v25, v25, s56, s56
    global_load_dwordx4 v[252:255], v65, s[100:101] offset:1024 sc1
    v_fma_f32 v26, v26, s56, s56
    v_fma_f32 v27, v27, s56, s56
    v_fma_f32 v28, v28, s56, s56
    v_fma_f32 v29, v29, s56, s56
    v_fma_f32 v30, v30, s56, s56
    v_fma_f32 v31, v31, s56, s56
    v_rcp_f32 v24, v24
    v_rcp_f32 v25, v25
    v_rcp_f32 v26, v26
    v_rcp_f32 v27, v27
    v_rcp_f32 v28, v28
    v_rcp_f32 v29, v29
    v_rcp_f32 v30, v30
    v_rcp_f32 v31, v31
    s_nop 0
    v_mul_f32 v16, v16, v24
    v_mul_f32 v17, v17, v25
    v_mul_f32 v18, v18, v26
    v_mul_f32 v19, v19, v27
    v_mul_f32 v20, v20, v28
    v_mul_f32 v21, v21, v29
    v_mul_f32 v22, v22, v30
    v_mul_f32 v23, v23, v31
    v_cvt_pk_bf16_f32 v24, v16, v17
    v_cvt_pk_bf16_f32 v25, v18, v19
    v_cvt_pk_bf16_f32 v26, v20, v21
    v_cvt_pk_bf16_f32 v27, v22, v23
    s_mov_b64 exec, s[54:55]
    ds_write_b128 v71, v[24:27]
    s_mov_b64 exec, -1
    s_waitcnt lgkmcnt(0)
    s_barrier
c1_mf:
    s_setprio 1
    ds_read_b128 v[32:35], v2 offset:0
    ds_read_b128 v[36:39], v2 offset:272
    ds_read_b128 v[40:43], v2 offset:544
    ds_read_b128 v[44:47], v2 offset:5120
    ds_read_b128 v[48:51], v2 offset:5392
    ds_read_b128 v[52:55], v2 offset:5664
    ds_read_b128 v[56:59], v2 offset:10240
    s_waitcnt vmcnt(17) lgkmcnt(6)
    v_mfma_f32_32x32x16_bf16 v[80:95], v[32:35], v[184:187], 0
    ds_read_b128 v[60:63], v2 offset:10512
    s_waitcnt vmcnt(16) lgkmcnt(6)
    v_mfma_f32_32x32x16_bf16 v[80:95], v[36:39], v[188:191], v[80:95]
    ds_read_b128 v[32:35], v2 offset:10240
    s_waitcnt vmcnt(15) lgkmcnt(6)
    v_mfma_f32_32x32x16_bf16 v[80:95], v[40:43], v[192:195], v[80:95]
    ds_read_b128 v[36:39], v2 offset:10784
    s_waitcnt vmcnt(14) lgkmcnt(6)
    v_mfma_f32_32x32x16_bf16 v[80:95], v[44:47], v[196:199], v[80:95]
    ds_read_b128 v[40:43], v2 offset:10512
    s_waitcnt vmcnt(13) lgkmcnt(6)
    v_mfma_f32_32x32x16_bf16 v[80:95], v[48:51], v[200:203], v[80:95]
    ds_read_b128 v[44:47], v2 offset:32
    s_waitcnt vmcnt(12) lgkmcnt(6)
    v_mfma_f32_32x32x16_bf16 v[80:95], v[52:55], v[204:207], v[80:95]
    ds_read_b128 v[48:51], v2 offset:10784
    s_waitcnt vmcnt(11) lgkmcnt(6)
    v_mfma_f32_32x32x16_bf16 v[80:95], v[56:59], v[208:211], v[80:95]
    ds_read_b128 v[52:55], v2 offset:304
    s_waitcnt vmcnt(10) lgkmcnt(6)
    v_mfma_f32_32x32x16_bf16 v[80:95], v[60:63], v[212:215], v[80:95]
    ds_read_b128 v[56:59], v2 offset:15360
    s_waitcnt lgkmcnt(6)
    v_mfma_f32_32x32x16_bf16 v[96:111], v[32:35], v[184:187], 0
    ds_read_b128 v[60:63], v2 offset:576
    s_waitcnt vmcnt(9) lgkmcnt(6)
    v_mfma_f32_32x32x16_bf16 v[80:95], v[36:39], v[216:219], v[80:95]
    ds_read_b128 v[32:35], v2 offset:15632
    s_waitcnt lgkmcnt(6)
    v_mfma_f32_32x32x16_bf16 v[96:111], v[40:43], v[188:191], v[96:111]
    ds_read_b128 v[36:39], v2 offset:5152
    s_waitcnt vmcnt(8) lgkmcnt(6)
    v_mfma_f32_32x32x16_bf16 v[80:95], v[44:47], v[220:223], v[80:95]
    ds_read_b128 v[40:43], v2 offset:15904
    s_waitcnt lgkmcnt(6)
    v_mfma_f32_32x32x16_bf16 v[96:111], v[48:51], v[192:195], v[96:111]
    ds_read_b128 v[44:47], v2 offset:5424
    s_waitcnt vmcnt(7) lgkmcnt(6)
    v_mfma_f32_32x32x16_bf16 v[80:95], v[52:55], v[224:227], v[80:95]
    ds_read_b128 v[48:51], v2 offset:20480
    s_waitcnt lgkmcnt(6)
    v_mfma_f32_32x32x16_bf16 v[96:111], v[56:59], v[196:199], v[96:111]
    ds_read_b128 v[52:55], v2 offset:5696
    s_waitcnt vmcnt(6) lgkmcnt(6)
    v_mfma_f32_32x32x16_bf16 v[80:95], v[60:63], v[228:231], v[80:95]
    ds_read_b128 v[56:59], v2 offset:20752
    s_waitcnt lgkmcnt(6)
    v_mfma_f32_32x32x16_bf16 v[96:111], v[32:35], v[200:203], v[96:111]
    ds_read_b128 v[60:63], v2 offset:10272
    s_waitcnt vmcnt(5) lgkmcnt(6)
    v_mfma_f32_32x32x16_bf16 v[80:95], v[36:39], v[232:235], v[80:95]
    ds_read_b128 v[32:35], v2 offset:21024
    s_waitcnt lgkmcnt(6)
    v_mfma_f32_32x32x16_bf16 v[96:111], v[40:43], v[204:207], v[96:111]
    ds_read_b128 v[36:39], v2 offset:10544
    s_waitcnt vmcnt(4) lgkmcnt(6)
    v_mfma_f32_32x32x16_bf16 v[80:95], v[44:47], v[236:239], v[80:95]
    ds_read_b128 v[40:43], v2 offset:10272
    s_waitcnt lgkmcnt(6)
    v_mfma_f32_32x32x16_bf16 v[96:111], v[48:51], v[208:211], v[96:111]
    ds_read_b128 v[44:47], v2 offset:10816
    s_waitcnt vmcnt(3) lgkmcnt(6)
    v_mfma_f32_32x32x16_bf16 v[80:95], v[52:55], v[240:243], v[80:95]
    ds_read_b128 v[48:51], v2 offset:10544
    s_waitcnt lgkmcnt(6)
    v_mfma_f32_32x32x16_bf16 v[96:111], v[56:59], v[212:215], v[96:111]
    ds_read_b128 v[52:55], v2 offset:10816
    s_waitcnt vmcnt(2) lgkmcnt(6)
    v_mfma_f32_32x32x16_bf16 v[80:95], v[60:63], v[244:247], v[80:95]
    ds_read_b128 v[56:59], v2 offset:15392
    s_waitcnt lgkmcnt(6)
    v_mfma_f32_32x32x16_bf16 v[96:111], v[32:35], v[216:219], v[96:111]
    ds_read_b128 v[60:63], v2 offset:15664
    s_waitcnt vmcnt(1) lgkmcnt(6)
    v_mfma_f32_32x32x16_bf16 v[80:95], v[36:39], v[248:251], v[80:95]
    ds_read_b128 v[32:35], v2 offset:15936
    s_waitcnt lgkmcnt(6)
    v_mfma_f32_32x32x16_bf16 v[96:111], v[40:43], v[220:223], v[96:111]
    ds_read_b128 v[36:39], v2 offset:20512
    s_waitcnt vmcnt(0) lgkmcnt(6)
    v_mfma_f32_32x32x16_bf16 v[80:95], v[44:47], v[252:255], v[80:95]
    ds_read_b128 v[40:43], v2 offset:20784
    s_waitcnt lgkmcnt(6)
    v_mfma_f32_32x32x16_bf16 v[96:111], v[48:51], v[224:227], v[96:111]
    ds_read_b128 v[44:47], v2 offset:21056
    s_waitcnt lgkmcnt(6)
    v_mfma_f32_32x32x16_bf16 v[96:111], v[52:55], v[228:231], v[96:111]
    ds_write_b128 v3, v[80:83] offset:0
    s_waitcnt lgkmcnt(6)
    v_mfma_f32_32x32x16_bf16 v[96:111], v[56:59], v[232:235], v[96:111]
    ds_write_b128 v3, v[84:87] offset:32
    s_waitcnt lgkmcnt(6)
    v_mfma_f32_32x32x16_bf16 v[96:111], v[60:63], v[236:239], v[96:111]
    ds_write_b128 v3, v[88:91] offset:64
    s_waitcnt lgkmcnt(6)
    v_mfma_f32_32x32x16_bf16 v[96:111], v[32:35], v[240:243], v[96:111]
    ds_write_b128 v3, v[92:95] offset:96
    s_waitcnt lgkmcnt(6)
    v_mfma_f32_32x32x16_bf16 v[96:111], v[36:39], v[244:247], v[96:111]
    s_waitcnt lgkmcnt(5)
    v_mfma_f32_32x32x16_bf16 v[96:111], v[40:43], v[248:251], v[96:111]
    s_waitcnt lgkmcnt(4)
    v_mfma_f32_32x32x16_bf16 v[96:111], v[44:47], v[252:255], v[96:111]
    s_setprio 0
    s_cmp_lt_u32 s33, 4
    s_cbranch_scc0 c1_hb
    s_barrier
c1_hb:
    s_nop 7
    s_nop 3
    ds_write_b128 v3, v[96:99] offset:128
    ds_write_b128 v3, v[100:103] offset:160
    ds_write_b128 v3, v[104:107] offset:192
    ds_write_b128 v3, v[108:111] offset:224
    s_waitcnt lgkmcnt(0)
    s_barrier
    v_lshrrev_b32 v2, 3, v0
    v_mul_u32_u24 v2, 272, v2
    v_and_b32 v3, 7, v0
    v_lshl_add_u32 v2, v3, 5, v2
    v_add_u32 v2, 30720, v2
    ds_read_b128 v[32:35], v2 offset:0
    ds_read_b128 v[36:39], v2 offset:16
    ds_read_b128 v[40:43], v2 offset:17408
    ds_read_b128 v[44:47], v2 offset:17424
    ds_read_b128 v[48:51], v2 offset:34816
    ds_read_b128 v[52:55], v2 offset:34832
    ds_read_b128 v[56:59], v2 offset:52224
    ds_read_b128 v[60:63], v2 offset:52240
    v_lshlrev_b32 v24, 16, v76
    v_and_b32 v25, 0xffff0000, v76
    v_lshlrev_b32 v26, 16, v77
    v_and_b32 v27, 0xffff0000, v77
    v_lshlrev_b32 v28, 16, v78
    v_and_b32 v29, 0xffff0000, v78
    v_lshlrev_b32 v30, 16, v79
    v_and_b32 v31, 0xffff0000, v79
    s_waitcnt lgkmcnt(4)
    v_pk_add_f32 v[32:33], v[32:33], v[40:41]
    v_pk_add_f32 v[34:35], v[34:35], v[42:43]
    v_pk_add_f32 v[36:37], v[36:37], v[44:45]
    v_pk_add_f32 v[38:39], v[38:39], v[46:47]
    v_pk_add_f32 v[32:33], v[32:33], v[24:25]
    v_pk_add_f32 v[34:35], v[34:35], v[26:27]
    v_pk_add_f32 v[36:37], v[36:37], v[28:29]
    v_pk_add_f32 v[38:39], v[38:39], v[30:31]
    s_waitcnt lgkmcnt(0)
    v_pk_add_f32 v[48:49], v[48:49], v[56:57]
    v_pk_add_f32 v[50:51], v[50:51], v[58:59]
    v_pk_add_f32 v[52:53], v[52:53], v[60:61]
    v_pk_add_f32 v[54:55], v[54:55], v[62:63]
    v_pk_add_f32 v[32:33], v[32:33], v[48:49]
    v_pk_add_f32 v[34:35], v[34:35], v[50:51]
    v_pk_add_f32 v[36:37], v[36:37], v[52:53]
    v_pk_add_f32 v[38:39], v[38:39], v[54:55]
    v_cvt_pk_bf16_f32 v16, v32, v33
    v_cvt_pk_bf16_f32 v17, v34, v35
    v_cvt_pk_bf16_f32 v18, v36, v37
    v_cvt_pk_bf16_f32 v19, v38, v39
    global_store_dwordx4 v67, v[16:19], s[22:23]
end:
    s_endpgm
.section .rodata,"a"
.p2align 6
.amdhsa_kernel standalone__adm_resblock__diffusion_kernel
  .amdhsa_next_free_vgpr 256
  .amdhsa_next_free_sgpr 102
  .amdhsa_accum_offset 256
  .amdhsa_group_segment_fixed_size 0
  .amdhsa_kernarg_size 96
  .amdhsa_user_sgpr_count 2
  .amdhsa_user_sgpr_kernarg_segment_ptr 1
  .amdhsa_system_sgpr_workgroup_id_x 1
.end_amdhsa_kernel
```
